```python
import torch

def _softmax(x, axis=-1):
    return torch.softmax(x, dim=axis)

def _gelu(x):
    return torch.nn.functional.gelu(x, approximate='tanh')

def _silu(x):
    return torch.nn.functional.silu(x)

def _sigmoid(x):
    return torch.sigmoid(x)

def _layernorm(x, axis=-1, eps=1e-05):
    m = x.mean(dim=axis, keepdim=True)
    v = x.var(dim=axis, keepdim=True, unbiased=False)
    return (x - m) / torch.sqrt(v + eps)

def _scatter_add(tgt, idx, src, axis=0):
    return tgt.clone().index_add_(axis, idx, src)

def _segment_sum(src, seg, n):
    out = torch.zeros((n,) + src.shape[1:], dtype=src.dtype)
    return out.index_add_(0, seg, src)

def _pad(x, pw):
    flat = tuple((v for pair in reversed(pw) for v in pair))
    return torch.nn.functional.pad(x, flat)
kernel_name = 'adaLN_cond__sliding_block_cached__glu_gated_swiglu__decode'

def setup_inputs():

    _w = lambda a: (lambda t: t.to(torch.bfloat16) if t.is_floating_point() else t)(torch.as_tensor(a))

    def _A_setup():
        B, Sq, D = (4, 1, 512)
        Hq, Hkv, Sk, Dh = (32, 8, 4096, 128)
        assert Hq % Hkv == 0, (Hq, Hkv)
        return {'x': _w((lambda *s: torch.randn(*s, dtype=torch.bfloat16) * 0.1)(B, Sq, D)), 'k_cache': _w((lambda *s: torch.randn(*s, dtype=torch.bfloat16) * 0.8)(B, Hkv, Sk, Dh)), 'v_cache': _w((lambda *s: torch.randn(*s, dtype=torch.bfloat16) * 3.2)(B, Hkv, Sk, Dh)), 'wq': _w((lambda *s: torch.randn(*s, dtype=torch.bfloat16) * 0.8)(D, Hq * Dh) * D ** (-0.5)), 'wo': _w((lambda *s: torch.randn(*s, dtype=torch.bfloat16) * 3.2)(Hq * Dh, D) * (Hq * Dh) ** (-0.5))}
    _A_in = _A_setup()

    def _B_setup():
        B, S, D, F = (4, 1, 512, 1792)
        return {'x': _w((lambda *s: torch.randn(*s, dtype=torch.bfloat16) * 0.1)(B, S, D)), 'w1': _w((lambda *s: torch.randn(*s, dtype=torch.bfloat16) * 3.2)(D, F) * (2.0 / D) ** 0.5), 'w3': _w((lambda *s: torch.randn(*s, dtype=torch.bfloat16) * 3.2)(D, F) * (2.0 / D) ** 0.5), 'w2': _w((lambda *s: torch.randn(*s, dtype=torch.bfloat16) * 3.2)(F, D) * (2.0 / F) ** 0.5)}
    _B_in = _B_setup()
    return {'A_x': _A_in['x'], 'A_k_cache': _A_in['k_cache'], 'A_v_cache': _A_in['v_cache'], 'A_wq': _A_in['wq'], 'A_wo': _A_in['wo'], 'B_x': _B_in['x'], 'B_w1': _B_in['w1'], 'B_w3': _B_in['w3'], 'B_w2': _B_in['w2'], 'c': _w((lambda *s: torch.randn(*s, dtype=torch.bfloat16) * 0.8)(4, 512) * 8.0), 'w_mod': _w((lambda *s: torch.randn(*s, dtype=torch.bfloat16) * 0.8)(512, 6 * 512) * 512 ** (-0.5) * 8.0)}

def reference(A_x, A_k_cache, A_v_cache, A_wq, A_wo, B_x, B_w1, B_w3, B_w2, c, w_mod):

    def _A_ref(x, k_cache, v_cache, wq, wo):
        B, Sq, D = x.shape
        Hq, Dh = (32, 128)
        Hkv, Sk = (k_cache.shape[1], k_cache.shape[2])
        W = min(4096, max(256, Sk // 4))
        rep = Hq // Hkv
        q = (lambda x, *d: x.permute(*d))((x @ wq).reshape(B, Sq, Hq, Dh), 0, 2, 1, 3)
        k = (lambda x, n, axis: torch.repeat_interleave(x, n, dim=axis))(k_cache[:, :, Sk - W:, :], rep, axis=1)
        v = (lambda x, n, axis: torch.repeat_interleave(x, n, dim=axis))(v_cache[:, :, Sk - W:, :], rep, axis=1)
        scores = torch.einsum('bhqd,bhkd->bhqk', q, k) * Dh ** (-0.5)
        p = _softmax(scores, axis=-1)
        o = torch.einsum('bhqk,bhkd->bhqd', p, v)
        return (lambda x, *d: x.permute(*d))(o, 0, 2, 1, 3).reshape(B, Sq, Hq * Dh) @ wo

    def _B_ref(x, w1, w3, w2):
        gate = torch.einsum('bsd,df->bsf', x, w1)
        up = torch.einsum('bsd,df->bsf', x, w3)
        h = _silu(gate) * up
        out = torch.einsum('bsf,fd->bsd', h, w2)
        return out
    x = A_x
    mod = (_silu(c) @ w_mod).reshape(c.shape[0], 6, 1, -1)
    sa, ca, ga, sb, cb, gb = (mod[:, 0].clone(), mod[:, 1].clone(), mod[:, 2].clone(), mod[:, 3].clone(), mod[:, 4].clone(), mod[:, 5].clone())
    h = _layernorm(x, axis=-1) * (1 + ca) + sa
    x = x + ga * _A_ref(h, A_k_cache, A_v_cache, A_wq, A_wo)
    h = _layernorm(x, axis=-1) * (1 + cb) + sb
    x = x + gb * _B_ref(h, B_w1, B_w3, B_w2)
    return x
```

```asm
; @launch grid=(256,1,1) block=(512,1,1) lds=163840
.amdgcn_target "amdgcn-amd-amdhsa--gfx950"
.text
.globl adaLN_cond__sliding_block_cached__glu_gated_swiglu__decode_kernel
.p2align 8
.type adaLN_cond__sliding_block_cached__glu_gated_swiglu__decode_kernel,@function
adaLN_cond__sliding_block_cached__glu_gated_swiglu__decode_kernel:
    s_cmp_ge_u32 s2, 256
    s_cbranch_scc1 L_end
    s_load_dwordx16 s[16:31], s[0:1], 0
    s_load_dwordx8 s[32:39], s[0:1], 64
    s_load_dwordx4 s[40:43], s[0:1], 96
    v_lshrrev_b32 v5, 6, v0
    v_and_b32 v1, 63, v0
    v_readfirstlane_b32 s3, v5
    v_and_b32 v2, 15, v0
    v_lshrrev_b32 v3, 4, v1
    s_and_b32 s12, s2, 7
    s_xor_b32 s12, s12, 3
    s_lshr_b32 s5, s2, 3
    s_mov_b32 s7, 400003
    s_mov_b32 s8, 0x05040100
    s_mov_b32 s9, 0x07060302
    s_mov_b32 s10, 0xffff0000
    s_mov_b32 s11, 0x3f803f80
    s_mov_b32 s101, 0xffffff00
    s_mov_b32 s98, 2621440
    s_cmp_eq_u32 s12, 3
    s_cbranch_scc1 L_roleM
    s_cmp_gt_u32 s12, 3
    s_subb_u32 s4, s12, 0
    s_cmp_lt_u32 s5, 16
    s_cbranch_scc1 L_roleA
    s_sub_u32 s5, s5, 16
    s_cmp_lt_u32 s5, 8
    s_cbranch_scc1 L_roleB
    s_sub_u32 s13, s5, 8
    s_cmp_lt_u32 s12, 4
    s_cbranch_scc1 L_spare
    s_lshl_b32 s5, s4, 3
    s_add_u32 s5, s5, s13
    s_sub_u32 s5, s5, 24
    s_branch L_roleD
L_spare:
    s_mov_b32 s4, 7
    s_mov_b32 s98, 0
    s_mul_i32 s5, s13, 3
    s_add_u32 s5, s5, s12
    s_cmp_lt_u32 s5, 16
    s_cbranch_scc1 L_roleA
    s_sub_u32 s5, s5, 16
    s_branch L_roleB
L_roleA:
    s_mov_b32 s12, s5
    s_lshr_b32 s13, s12, 2
    s_and_b32 s14, s12, 3
    s_lshl_b32 s15, s13, 3
    s_add_u32 s15, s15, s4
    s_lshl_b32 s68, s15, 20
    s_lshl_b32 s69, s14, 16
    s_add_u32 s68, s68, s69
    s_add_u32 s68, s68, 786432
    s_lshl_b32 s72, s3, 13
    s_mov_b32 s69, s72
    s_add_u32 s70, s69, 0x1000
    v_lshlrev_b32 v6, 10, v3
    v_lshl_add_u32 v6, v2, 4, v6
    v_lshlrev_b32 v7, 2, v3
    v_xor_b32 v7, v2, v7
    v_lshlrev_b32 v7, 4, v7
    v_lshl_add_u32 v112, v3, 8, v7
    v_xor_b32 v113, 16, v112
    v_xor_b32 v114, 32, v112
    v_xor_b32 v115, 48, v112
    s_add_u32 s71, s72, 32768
    s_mov_b32 m0, s71
    s_waitcnt lgkmcnt(0)
    s_mov_b32 s44, s42
    s_mov_b32 s45, s43
    s_mov_b32 s46, 5242880
    s_mov_b32 s47, 0x00020000
    buffer_load_dword v4, off, s[44:47], 0 sc1
    s_add_u32 s52, s18, s68
    s_addc_u32 s53, s19, 0
    s_mov_b32 s54, 65536
    s_mov_b32 s55, 0x00020000
    s_lshl_b32 s76, s13, 14
    s_lshl_b32 s77, s4, 11
    s_add_u32 s76, s76, s77
    s_add_u32 s76, s76, 65536
    s_add_u32 s76, s76, s98
    v_lshlrev_b32 v8, 2, v0
    buffer_load_dword v255, v8, s[44:47], s76 offen sc1
    buffer_load_dwordx4 v112, s[52:55], s69 offen offset:0 nt lds
    buffer_load_dwordx4 v113, s[52:55], s69 offen offset:1024 nt lds
    buffer_load_dwordx4 v114, s[52:55], s69 offen offset:2048 nt lds
    buffer_load_dwordx4 v115, s[52:55], s69 offen offset:3072 nt lds
    s_waitcnt vmcnt(0)
    s_barrier
    s_add_u32 m0, s71, 0x1000
    s_nop 0
    buffer_load_dwordx4 v112, s[52:55], s70 offen offset:0 nt lds
    buffer_load_dwordx4 v113, s[52:55], s70 offen offset:1024 nt lds
    buffer_load_dwordx4 v114, s[52:55], s70 offen offset:2048 nt lds
    buffer_load_dwordx4 v115, s[52:55], s70 offen offset:3072 nt lds
    s_add_u32 s48, s20, s68
    s_addc_u32 s49, s21, 0
    s_mov_b32 s50, 65536
    s_mov_b32 s51, 0x00020000
    buffer_load_dwordx4 v[16:19], v6, s[48:51], s69 offen offset:0 nt
    buffer_load_dwordx4 v[20:23], v6, s[48:51], s69 offen offset:256 nt
    buffer_load_dwordx4 v[24:27], v6, s[48:51], s69 offen offset:512 nt
    buffer_load_dwordx4 v[28:31], v6, s[48:51], s69 offen offset:768 nt
    buffer_load_dwordx4 v[32:35], v6, s[48:51], s70 offen offset:0 nt
    buffer_load_dwordx4 v[36:39], v6, s[48:51], s70 offen offset:256 nt
    buffer_load_dwordx4 v[40:43], v6, s[48:51], s70 offen offset:512 nt
    buffer_load_dwordx4 v[44:47], v6, s[48:51], s70 offen offset:768 nt
    v_and_b32 v7, 3, v2
    v_xor_b32 v7, v7, v3
    v_lshlrev_b32 v7, 2, v7
    v_lshrrev_b32 v8, 2, v2
    v_or_b32 v7, v7, v8
    v_lshlrev_b32 v7, 4, v7
    v_lshl_add_u32 v116, v2, 8, v7
    v_add_u32 v116, s71, v116
    v_xor_b32 v117, 16, v116
    v_xor_b32 v118, 32, v116
    v_xor_b32 v119, 48, v116
    v_and_b32 v8, 3, v1
    v_lshlrev_b32 v7, 5, v8
    v_lshrrev_b32 v8, 2, v2
    v_lshl_add_u32 v7, v8, 9, v7
    v_lshl_add_u32 v7, v3, 7, v7
    s_lshl_b32 s76, s13, 14
    s_lshl_b32 s77, s4, 11
    s_add_u32 s76, s76, s77
    s_add_u32 s76, s76, 65536
    s_mul_i32 s77, s3, 2112
    v_mul_u32_u24 v9, 528, v8
    v_lshl_add_u32 v9, v3, 7, v9
    v_add_u32 v9, s77, v9
    s_lshl_b32 s77, s3, 3
    v_lshlrev_b32 v10, 6, v8
    v_add_u32 v10, s77, v10
    s_mul_i32 s77, s3, 528
    v_lshlrev_b32 v122, 3, v1
    v_add_u32 v120, s77, v122
    s_lshl_b32 s77, s3, 6
    v_and_b32 v121, 7, v1
    v_lshlrev_b32 v121, 3, v121
    v_add_u32 v121, s77, v121
    s_lshl_b32 s78, s15, 2
    s_add_u32 s78, s78, s14
    s_lshl_b32 s79, s78, 2
    s_add_u32 s79, s79, s3
    s_lshl_b32 s78, s79, 9
    s_add_u32 s78, s78, 262144
    s_lshl_b32 s79, s79, 4
    s_add_u32 s79, s79, 131072
    v_lshlrev_b32 v127, 4, v1
    v_add_u32 v127, 20480, v127
    v_and_b32 v115, 0xffffffc0, v127
    v_and_b32 v8, 3, v1
    v_cmp_eq_u32 s[36:37], 0, v8
    v_cmp_eq_u32 s[38:39], 1, v8
    v_cmp_eq_u32 s[40:41], 2, v8
    v_cmp_eq_u32 s[42:43], 3, v8
    v_cndmask_b32 v212, 0, -1, s[36:37]
    v_cndmask_b32 v213, 0, -1, s[38:39]
    v_cndmask_b32 v214, 0, -1, s[40:41]
    v_cndmask_b32 v215, 0, -1, s[42:43]
    v_cmp_lt_u32 s[34:35], 1, v8
    v_lshl_add_u32 v9, v8, 5, v9
    s_mov_b32 s68, 0x3db504f3
    s_mov_b32 s69, 0x3db504f3
    s_mov_b32 s14, 0x3fb8aa3b
    s_mov_b32 s15, 0x3fb8aa3b
L_A_go:
    s_waitcnt vmcnt(16)
    v_readfirstlane_b32 s6, v4
    s_nop 3
    s_and_b32 s100, s6, 0xff
    s_add_u32 s100, s100, 1
    s_cmp_eq_u32 s100, 0x100
    s_cselect_b32 s100, 1, s100
    s_add_u32 s6, s6, 0x100
    s_andn2_b32 s6, s6, 0xff
    s_or_b32 s6, s6, s100
    v_mov_b32 v4, s6
    v_mov_b32 v5, s100
    s_and_b32 s97, s100, 3
    s_waitcnt vmcnt(8)
    ds_read_b128 v[48:51], v116 offset:0
    ds_read_b128 v[52:55], v117 offset:0
    ds_read_b128 v[56:59], v118 offset:0
    ds_read_b128 v[60:63], v119 offset:0
    ds_read_b128 v[64:67], v116 offset:4096
    ds_read_b128 v[68:71], v117 offset:4096
    ds_read_b128 v[72:75], v118 offset:4096
    ds_read_b128 v[76:79], v119 offset:4096
    s_waitcnt vmcnt(6)
    v_perm_b32 v80, v20, v16, s8
    v_perm_b32 v84, v20, v16, s9
    v_perm_b32 v88, v21, v17, s8
    v_perm_b32 v92, v21, v17, s9
    v_perm_b32 v96, v22, v18, s8
    v_perm_b32 v100, v22, v18, s9
    v_perm_b32 v104, v23, v19, s8
    v_perm_b32 v108, v23, v19, s9
    s_waitcnt vmcnt(4)
    v_perm_b32 v81, v28, v24, s8
    v_perm_b32 v85, v28, v24, s9
    v_perm_b32 v89, v29, v25, s8
    v_perm_b32 v93, v29, v25, s9
    v_perm_b32 v97, v30, v26, s8
    v_perm_b32 v101, v30, v26, s9
    v_perm_b32 v105, v31, v27, s8
    v_perm_b32 v109, v31, v27, s9
    s_waitcnt vmcnt(2)
    v_perm_b32 v82, v36, v32, s8
    v_perm_b32 v86, v36, v32, s9
    v_perm_b32 v90, v37, v33, s8
    v_perm_b32 v94, v37, v33, s9
    v_perm_b32 v98, v38, v34, s8
    v_perm_b32 v102, v38, v34, s9
    v_perm_b32 v106, v39, v35, s8
    v_perm_b32 v110, v39, v35, s9
    s_waitcnt vmcnt(0)
    v_perm_b32 v83, v44, v40, s8
    v_perm_b32 v87, v44, v40, s9
    v_perm_b32 v91, v45, v41, s8
    v_perm_b32 v95, v45, v41, s9
    v_perm_b32 v99, v46, v42, s8
    v_perm_b32 v103, v46, v42, s9
    v_perm_b32 v107, v47, v43, s8
    v_perm_b32 v111, v47, v43, s9
    v_mov_b32 v205, v4
    v_mov_b32 v207, v4
    s_barrier
    s_cmp_lg_u32 s3, 0
    s_cbranch_scc1 Lqw_1
    s_or_b32 s7, s7, 15
Lpoll_2:
    s_and_b32 s66, s7, 15
    s_cselect_b32 s66, s98, 0
    s_add_u32 s64, s76, s66
    buffer_load_dwordx4 v[216:219], v7, s[44:47], s64 offen sc1
    buffer_load_dwordx4 v[220:223], v7, s[44:47], s64 offen offset:16 sc1
    s_waitcnt vmcnt(0)
    v_sad_u32 v11, v217, s6, 0
    v_sad_u32 v11, v219, s6, v11
    v_sad_u32 v11, v221, s6, v11
    v_sad_u32 v11, v223, s6, v11
    v_cmp_ne_u32 vcc, 0, v11
    s_cbranch_vccz Lgot_3
    s_sub_u32 s7, s7, 1
    s_cbranch_scc0 Lpoll_2
    s_branch L_exit
Lgot_3:
    ds_write2_b32 v127, v216, v218 offset0:0 offset1:1
    ds_write2_b32 v127, v220, v222 offset0:2 offset1:3
    s_waitcnt lgkmcnt(0)
Lqw_1:
    s_barrier
    ds_read_b128 v[136:139], v115 offset:0
    ds_read_b128 v[140:143], v115 offset:16
    ds_read_b128 v[144:147], v115 offset:32
    ds_read_b128 v[148:151], v115 offset:48
    s_waitcnt lgkmcnt(3)
    v_mfma_f32_16x16x32_bf16 v[152:155], v[48:51], v[136:139], 0
    v_mfma_f32_16x16x32_bf16 v[156:159], v[64:67], v[136:139], 0
    s_waitcnt lgkmcnt(2)
    v_mfma_f32_16x16x32_bf16 v[152:155], v[52:55], v[140:143], v[152:155]
    v_mfma_f32_16x16x32_bf16 v[156:159], v[68:71], v[140:143], v[156:159]
    s_waitcnt lgkmcnt(1)
    v_mfma_f32_16x16x32_bf16 v[152:155], v[56:59], v[144:147], v[152:155]
    v_mfma_f32_16x16x32_bf16 v[156:159], v[72:75], v[144:147], v[156:159]
    s_waitcnt lgkmcnt(0)
    v_mfma_f32_16x16x32_bf16 v[152:155], v[60:63], v[148:151], v[152:155]
    v_mfma_f32_16x16x32_bf16 v[156:159], v[76:79], v[148:151], v[156:159]
    s_nop 6
    v_cndmask_b32 v128, v152, v154, s[38:39]
    v_cndmask_b32 v130, v156, v158, s[42:43]
    v_cndmask_b32 v129, v153, v155, s[38:39]
    v_cndmask_b32 v131, v157, v159, s[42:43]
    v_cndmask_b32 v128, v128, v130, s[34:35]
    v_cndmask_b32 v129, v129, v131, s[34:35]
    v_cvt_pk_bf16_f32 v130, v128, v129
    v_lshlrev_b32 v128, 16, v130
    v_and_b32 v129, s10, v130
    v_pk_mul_f32 v[128:129], v[128:129], s[68:69]
    v_cvt_pk_bf16_f32 v130, v128, v129
    v_lshlrev_b32 v128, 16, v130
    v_and_b32 v129, s10, v130
    v_max_f32 v12, v128, v129
    s_nop 1
    v_max_f32_dpp v12, v12, v12 quad_perm:[1,0,3,2] row_mask:0xf bank_mask:0xf
    s_nop 1
    v_max_f32_dpp v12, v12, v12 quad_perm:[2,3,0,1] row_mask:0xf bank_mask:0xf
    v_mov_b32 v13, v12
    s_nop 1
    v_permlane16_swap_b32 v12, v13
    v_max_f32 v12, v12, v13
    v_mov_b32 v13, v12
    s_nop 1
    v_permlane32_swap_b32 v12, v13
    v_max_f32 v12, v12, v13
    v_mul_f32 v12, s14, v12
    v_fma_f32 v128, v128, s14, -v12
    v_fma_f32 v129, v129, s14, -v12
    v_exp_f32 v128, v128
    v_exp_f32 v129, v129
    s_nop 0
    v_cvt_pk_bf16_f32 v130, v128, v129
    v_add_f32 v13, v128, v129
    s_nop 0
    v_and_b32_dpp v136, v130, v212 quad_perm:[0,0,0,0] row_mask:0xf bank_mask:0xf
    v_and_b32_dpp v137, v130, v212 quad_perm:[1,1,1,1] row_mask:0xf bank_mask:0xf
    v_and_b32_dpp v138, v130, v212 quad_perm:[2,2,2,2] row_mask:0xf bank_mask:0xf
    v_and_b32_dpp v139, v130, v212 quad_perm:[3,3,3,3] row_mask:0xf bank_mask:0xf
    s_nop 1
    v_mfma_f32_16x16x32_bf16 v[168:171], v[80:83], v[136:139], 0
    v_mfma_f32_16x16x32_bf16 v[172:175], v[84:87], v[136:139], 0
    v_and_b32_dpp v140, v130, v213 quad_perm:[0,0,0,0] row_mask:0xf bank_mask:0xf
    v_and_b32_dpp v141, v130, v213 quad_perm:[1,1,1,1] row_mask:0xf bank_mask:0xf
    v_and_b32_dpp v142, v130, v213 quad_perm:[2,2,2,2] row_mask:0xf bank_mask:0xf
    v_and_b32_dpp v143, v130, v213 quad_perm:[3,3,3,3] row_mask:0xf bank_mask:0xf
    v_add_f32_dpp v13, v13, v13 quad_perm:[1,0,3,2] row_mask:0xf bank_mask:0xf
    s_nop 1
    v_add_f32_dpp v13, v13, v13 quad_perm:[2,3,0,1] row_mask:0xf bank_mask:0xf
    v_mfma_f32_16x16x32_bf16 v[168:171], v[88:91], v[140:143], v[168:171]
    v_mfma_f32_16x16x32_bf16 v[172:175], v[92:95], v[140:143], v[172:175]
    v_and_b32_dpp v144, v130, v214 quad_perm:[0,0,0,0] row_mask:0xf bank_mask:0xf
    v_and_b32_dpp v145, v130, v214 quad_perm:[1,1,1,1] row_mask:0xf bank_mask:0xf
    v_and_b32_dpp v146, v130, v214 quad_perm:[2,2,2,2] row_mask:0xf bank_mask:0xf
    v_and_b32_dpp v147, v130, v214 quad_perm:[3,3,3,3] row_mask:0xf bank_mask:0xf
    v_mov_b32 v14, v13
    s_nop 1
    v_permlane16_swap_b32 v13, v14
    v_mfma_f32_16x16x32_bf16 v[168:171], v[96:99], v[144:147], v[168:171]
    v_mfma_f32_16x16x32_bf16 v[172:175], v[100:103], v[144:147], v[172:175]
    v_and_b32_dpp v148, v130, v215 quad_perm:[0,0,0,0] row_mask:0xf bank_mask:0xf
    v_and_b32_dpp v149, v130, v215 quad_perm:[1,1,1,1] row_mask:0xf bank_mask:0xf
    v_and_b32_dpp v150, v130, v215 quad_perm:[2,2,2,2] row_mask:0xf bank_mask:0xf
    v_and_b32_dpp v151, v130, v215 quad_perm:[3,3,3,3] row_mask:0xf bank_mask:0xf
    v_add_f32 v13, v13, v14
    v_mov_b32 v14, v13
    v_mfma_f32_16x16x32_bf16 v[168:171], v[104:107], v[148:151], v[168:171]
    v_mfma_f32_16x16x32_bf16 v[172:175], v[108:111], v[148:151], v[172:175]
    v_permlane32_swap_b32 v13, v14
    v_add_f32 v13, v13, v14
    s_mov_b64 s[60:61], exec
    s_and_b64 exec, exec, 0x1111
    ds_write_b64 v10, v[12:13] offset:16896
    s_mov_b64 exec, s[60:61]
    s_nop 0
    ds_write_b128 v9, v[168:171] offset:0
    ds_write_b128 v9, v[172:175] offset:16
    s_waitcnt lgkmcnt(0)
    s_barrier
    s_cmp_ge_u32 s3, 4
    s_cbranch_scc1 L_exit
    ds_read_b64 v[144:145], v121 offset:16896
    ds_read_b64 v[128:129], v120 offset:0
    ds_read_b64 v[130:131], v120 offset:2112
    ds_read_b64 v[132:133], v120 offset:4224
    ds_read_b64 v[134:135], v120 offset:6336
    ds_read_b64 v[136:137], v120 offset:8448
    ds_read_b64 v[138:139], v120 offset:10560
    ds_read_b64 v[140:141], v120 offset:12672
    ds_read_b64 v[142:143], v120 offset:14784
    s_waitcnt lgkmcnt(8)
    v_max_f32_dpp v204, v144, v144 quad_perm:[1,0,3,2] row_mask:0xf bank_mask:0xf
    s_nop 1
    v_max_f32_dpp v204, v204, v204 quad_perm:[2,3,0,1] row_mask:0xf bank_mask:0xf
    s_nop 1
    v_max_f32_dpp v204, v204, v204 row_half_mirror row_mask:0xf bank_mask:0xf
    v_sub_f32 v146, v144, v204
    v_exp_f32 v146, v146
    s_nop 0
    v_mul_f32 v206, v146, v145
    v_readlane_b32 s60, v146, 0
    v_readlane_b32 s61, v146, 1
    v_readlane_b32 s62, v146, 2
    v_readlane_b32 s63, v146, 3
    v_readlane_b32 s64, v146, 4
    v_readlane_b32 s65, v146, 5
    v_readlane_b32 s66, v146, 6
    v_readlane_b32 s67, v146, 7
    s_waitcnt lgkmcnt(0)
    v_mul_f32 v200, s60, v128
    v_mul_f32 v201, s60, v129
    v_fmac_f32 v200, s61, v130
    v_fmac_f32 v201, s61, v131
    v_fmac_f32 v200, s62, v132
    v_fmac_f32 v201, s62, v133
    v_fmac_f32 v200, s63, v134
    v_fmac_f32 v201, s63, v135
    v_fmac_f32 v200, s64, v136
    v_fmac_f32 v201, s64, v137
    v_fmac_f32 v200, s65, v138
    v_fmac_f32 v201, s65, v139
    v_fmac_f32 v200, s66, v140
    v_fmac_f32 v201, s66, v141
    v_fmac_f32 v200, s67, v142
    v_fmac_f32 v201, s67, v143
    v_and_or_b32 v200, v200, s101, v5
    v_and_or_b32 v201, v201, s101, v5
    s_add_u32 s66, s78, 2621440
    buffer_store_dwordx2 v[200:201], v122, s[44:47], s66 offen
    buffer_store_dwordx2 v[200:201], v122, s[44:47], s78 offen sc1
    v_add_f32_dpp v206, v206, v206 quad_perm:[1,0,3,2] row_mask:0xf bank_mask:0xf
    s_nop 1
    v_add_f32_dpp v206, v206, v206 quad_perm:[2,3,0,1] row_mask:0xf bank_mask:0xf
    s_nop 1
    v_add_f32_dpp v206, v206, v206 row_half_mirror row_mask:0xf bank_mask:0xf
    s_mov_b64 exec, 1
    s_add_u32 s66, s79, 2621440
    buffer_store_dwordx4 v[204:207], off, s[44:47], s66
    buffer_store_dwordx4 v[204:207], off, s[44:47], s79 sc1
    s_mov_b64 exec, -1
    s_branch L_exit
L_roleB:
    s_lshl_b32 s12, s4, 3
    s_add_u32 s12, s12, s5
    s_lshl_b32 s13, s12, 7
    v_lshlrev_b32 v9, 10, v3
    s_lshl_b32 s14, s3, 7
    v_lshl_add_u32 v8, v2, 3, v9
    v_lshrrev_b32 v6, 3, v1
    v_and_b32 v7, 7, v1
    v_lshlrev_b32 v7, 4, v7
    v_lshl_add_u32 v118, v6, 10, v7
    v_lshl_add_u32 v7, v6, 13, v7
    s_lshl_b32 s15, s3, 19
    s_lshl_b32 s75, s3, 13
    s_waitcnt lgkmcnt(0)
    s_mov_b32 s44, s42
    s_mov_b32 s45, s43
    s_mov_b32 s46, 5242880
    s_mov_b32 s47, 0x00020000
    buffer_load_dword v4, off, s[44:47], 0 sc1
    s_mov_b32 s56, s16
    s_mov_b32 s57, s17
    s_mov_b32 s58, 4096
    s_mov_b32 s59, 0x00020000
    buffer_load_dwordx2 v[96:97], v8, s[56:59], s14 offen
    s_add_u32 s48, s22, s13
    s_addc_u32 s49, s23, 0
    s_mov_b32 s50, 4186240
    s_mov_b32 s51, 0x00020000
    s_add_u32 m0, s75, 32768
    s_nop 0
    buffer_load_dwordx4 v7, s[48:51], s15 offen nt lds
    s_add_u32 m0, s75, 33792
    s_add_u32 s15, s15, 65536
    buffer_load_dwordx4 v7, s[48:51], s15 offen nt lds
    s_add_u32 m0, s75, 34816
    s_add_u32 s15, s15, 65536
    buffer_load_dwordx4 v7, s[48:51], s15 offen nt lds
    s_add_u32 m0, s75, 35840
    s_add_u32 s15, s15, 65536
    buffer_load_dwordx4 v7, s[48:51], s15 offen nt lds
    s_add_u32 m0, s75, 36864
    s_add_u32 s15, s15, 65536
    buffer_load_dwordx4 v7, s[48:51], s15 offen nt lds
    s_add_u32 m0, s75, 37888
    s_add_u32 s15, s15, 65536
    buffer_load_dwordx4 v7, s[48:51], s15 offen nt lds
    s_add_u32 m0, s75, 38912
    s_add_u32 s15, s15, 65536
    buffer_load_dwordx4 v7, s[48:51], s15 offen nt lds
    s_add_u32 m0, s75, 39936
    s_add_u32 s15, s15, 65536
    buffer_load_dwordx4 v7, s[48:51], s15 offen nt lds
    s_lshl_b32 s68, s3, 8
    s_add_u32 s68, s68, 524288
    s_add_u32 s69, s68, 16384
    v_lshlrev_b32 v8, 12, v3
    v_lshl_add_u32 v8, v2, 4, v8
    s_lshl_b32 s70, s3, 9
    v_lshrrev_b32 v9, 3, v2
    v_lshlrev_b32 v9, 8, v9
    v_lshl_add_u32 v9, v3, 6, v9
    v_and_b32 v10, 7, v2
    v_lshl_add_u32 v9, v10, 3, v9
    v_add_u32 v9, s70, v9
    v_lshrrev_b32 v10, 2, v2
    v_add_u32 v10, v10, v2
    v_and_b32 v10, 3, v10
    v_lshlrev_b32 v12, 6, v10
    v_lshl_add_u32 v12, v3, 4, v12
    v_add_u32 v13, s70, v12
    s_lshl_b32 s71, s3, 10
    s_add_u32 s71, s71, 4096
    v_lshlrev_b32 v14, 8, v3
    v_lshl_add_u32 v14, v2, 4, v14
    v_add_u32 v14, s71, v14
    v_lshlrev_b32 v112, 3, v0
    v_lshrrev_b32 v113, 5, v0
    v_lshlrev_b32 v113, 14, v113
    v_and_b32 v10, 31, v0
    v_lshl_add_u32 v113, v10, 3, v113
    s_lshl_b32 s76, s12, 8
    s_add_u32 s76, s76, 65536
    s_lshl_b32 s13, s12, 16
    s_add_u32 s52, s24, s13
    s_addc_u32 s53, s25, 0
    s_mov_b32 s54, 65536
    s_mov_b32 s55, 0x00020000
    s_lshl_b32 s74, s3, 7
    v_lshlrev_b32 v119, 3, v2
    v_add_u32 v119, s75, v119
    v_lshl_add_u32 v120, v3, 8, v119
    v_add_u32 v120, 0x10000, v120
    v_lshl_add_u32 v119, v3, 10, v119
    v_lshrrev_b32 v15, 7, v0
    v_lshl_add_u32 v6, v15, 5, v3
    v_bfe_u32 v10, v0, 6, 1
    v_lshl_add_u32 v10, v10, 4, v2
    v_lshlrev_b32 v114, 11, v6
    v_lshl_add_u32 v114, v10, 3, v114
    v_lshlrev_b32 v115, 6, v6
    s_lshl_b32 s13, s4, 13
    s_and_b32 s14, s12, 7
    s_lshl_b32 s14, s14, 8
    s_add_u32 s13, s13, s14
    s_add_u32 s77, s13, 262144
    s_lshl_b32 s13, s4, 8
    s_lshr_b32 s14, s12, 1
    s_and_b32 s14, s14, 3
    s_lshl_b32 s14, s14, 4
    s_add_u32 s13, s13, s14
    s_add_u32 s78, s13, 131072
    v_lshrrev_b32 v116, 4, v10
    v_lshlrev_b32 v116, 8, v116
    v_lshl_add_u32 v116, v15, 6, v116
    v_and_b32 v10, 15, v10
    v_lshl_add_u32 v116, v10, 2, v116
    s_mul_i32 s79, s12, 8448
    s_lshl_b32 s13, s3, 8
    s_add_u32 s79, s79, s13
    s_add_u32 s79, s79, 1048576
    v_lshlrev_b32 v117, 11, v3
    v_lshl_add_u32 v117, v2, 4, v117
    s_add_u32 s64, s78, s98
    s_add_u32 s65, s77, s98
    buffer_load_dwordx4 v[224:227], v115, s[44:47], s64 offen sc1
    buffer_load_dwordx2 v[228:229], v114, s[44:47], s65 offen sc1
    s_lshl_b32 s13, s3, 3
    v_lshlrev_b32 v121, 6, v3
    v_add_u32 v122, s13, v121
    s_waitcnt vmcnt(10)
    v_readfirstlane_b32 s6, v4
    s_nop 3
    s_and_b32 s100, s6, 0xff
    s_add_u32 s100, s100, 1
    s_cmp_eq_u32 s100, 0x100
    s_cselect_b32 s100, 1, s100
    s_add_u32 s6, s6, 0x100
    s_andn2_b32 s6, s6, 0xff
    s_or_b32 s6, s6, s100
    v_mov_b32 v4, s6
    v_mov_b32 v5, s100
    s_and_b32 s97, s100, 3
    v_mov_b32 v102, 0
    v_mov_b32 v103, 0
    v_dot2c_f32_bf16 v102, s11, v96
    v_dot2c_f32_bf16 v103, v96, v96
    v_dot2c_f32_bf16 v102, s11, v97
    v_dot2c_f32_bf16 v103, v97, v97
    s_nop 1
    v_add_f32_dpp v102, v102, v102 row_ror:8 row_mask:0xf bank_mask:0xf
    v_add_f32_dpp v103, v103, v103 row_ror:8 row_mask:0xf bank_mask:0xf
    s_nop 0
    v_add_f32_dpp v102, v102, v102 row_ror:4 row_mask:0xf bank_mask:0xf
    v_add_f32_dpp v103, v103, v103 row_ror:4 row_mask:0xf bank_mask:0xf
    s_nop 0
    v_add_f32_dpp v102, v102, v102 row_ror:2 row_mask:0xf bank_mask:0xf
    v_add_f32_dpp v103, v103, v103 row_ror:2 row_mask:0xf bank_mask:0xf
    s_nop 0
    v_add_f32_dpp v102, v102, v102 row_ror:1 row_mask:0xf bank_mask:0xf
    v_add_f32_dpp v103, v103, v103 row_ror:1 row_mask:0xf bank_mask:0xf
    ds_write_b64 v122, v[102:103] offset:13312
    s_waitcnt lgkmcnt(0)
    s_barrier
    ds_read_b128 v[80:83], v121 offset:13312
    ds_read_b128 v[84:87], v121 offset:13328
    ds_read_b128 v[88:91], v121 offset:13344
    ds_read_b128 v[92:95], v121 offset:13360
    s_waitcnt lgkmcnt(0)
    v_pk_add_f32 v[80:81], v[80:81], v[82:83]
    v_pk_add_f32 v[80:81], v[80:81], v[84:85]
    v_pk_add_f32 v[80:81], v[80:81], v[86:87]
    v_pk_add_f32 v[80:81], v[80:81], v[88:89]
    v_pk_add_f32 v[80:81], v[80:81], v[90:91]
    v_pk_add_f32 v[80:81], v[80:81], v[92:93]
    v_pk_add_f32 v[80:81], v[80:81], v[94:95]
    v_mov_b32 v102, v80
    v_mov_b32 v103, v81
    v_mul_f32 v102, 0x3b000000, v102
    v_mul_f32 v103, 0x3b000000, v103
    v_fma_f32 v103, -v102, v102, v103
    v_max_f32 v103, 0, v103
    v_cvt_pk_bf16_f32 v10, v102, v103
    v_lshlrev_b32 v102, 16, v10
    v_and_b32 v103, s10, v10
    v_add_f32 v103, 0x3727c5ac, v103
    v_cvt_pk_bf16_f32 v10, v103, v103
    v_lshlrev_b32 v103, 16, v10
    v_sqrt_f32 v103, v103
    s_nop 0
    v_cvt_pk_bf16_f32 v10, v103, v103
    v_lshlrev_b32 v103, 16, v10
    v_rcp_f32 v103, v103
    v_lshlrev_b32 v104, 16, v10
    v_lshlrev_b32 v98, 16, v96
    v_and_b32 v99, s10, v96
    v_lshlrev_b32 v100, 16, v97
    v_and_b32 v101, s10, v97
    v_sub_f32 v98, v98, v102
    v_sub_f32 v99, v99, v102
    v_sub_f32 v100, v100, v102
    v_sub_f32 v101, v101, v102
    v_cvt_pk_bf16_f32 v10, v98, v99
    v_cvt_pk_bf16_f32 v11, v100, v101
    v_lshlrev_b32 v98, 16, v10
    v_and_b32 v99, s10, v10
    v_lshlrev_b32 v100, 16, v11
    v_and_b32 v101, s10, v11
    v_mul_f32 v105, v98, v103
    v_fma_f32 v106, -v105, v104, v98
    v_fma_f32 v98, v106, v103, v105
    v_mul_f32 v105, v99, v103
    v_fma_f32 v106, -v105, v104, v99
    v_fma_f32 v99, v106, v103, v105
    v_mul_f32 v105, v100, v103
    v_fma_f32 v106, -v105, v104, v100
    v_fma_f32 v100, v106, v103, v105
    v_mul_f32 v105, v101, v103
    v_fma_f32 v106, -v105, v104, v101
    v_fma_f32 v101, v106, v103, v105
    v_cvt_pk_bf16_f32 v10, v98, v99
    v_cvt_pk_bf16_f32 v11, v100, v101
    v_lshlrev_b32 v98, 16, v10
    v_and_b32 v99, s10, v10
    v_lshlrev_b32 v100, 16, v11
    v_and_b32 v101, s10, v11
    v_mov_b32 v153, v4
L_B_go:
    s_waitcnt vmcnt(0)
    ds_read_b64 v[16:17], v119 offset:32768
    ds_read_b64 v[18:19], v119 offset:32896
    ds_read_b64 v[20:21], v119 offset:33024
    ds_read_b64 v[22:23], v119 offset:33152
    ds_read_b64 v[24:25], v119 offset:33280
    ds_read_b64 v[26:27], v119 offset:33408
    ds_read_b64 v[28:29], v119 offset:33536
    ds_read_b64 v[30:31], v119 offset:33664
    ds_read_b64 v[32:33], v119 offset:36864
    ds_read_b64 v[34:35], v119 offset:36992
    ds_read_b64 v[36:37], v119 offset:37120
    ds_read_b64 v[38:39], v119 offset:37248
    ds_read_b64 v[40:41], v119 offset:37376
    ds_read_b64 v[42:43], v119 offset:37504
    ds_read_b64 v[44:45], v119 offset:37632
    ds_read_b64 v[46:47], v119 offset:37760
    s_waitcnt lgkmcnt(0)
    v_perm_b32 v48, v18, v16, s8
    v_perm_b32 v49, v22, v20, s8
    v_perm_b32 v50, v26, v24, s8
    v_perm_b32 v51, v30, v28, s8
    v_perm_b32 v52, v18, v16, s9
    v_perm_b32 v53, v22, v20, s9
    v_perm_b32 v54, v26, v24, s9
    v_perm_b32 v55, v30, v28, s9
    v_perm_b32 v56, v19, v17, s8
    v_perm_b32 v57, v23, v21, s8
    v_perm_b32 v58, v27, v25, s8
    v_perm_b32 v59, v31, v29, s8
    v_perm_b32 v60, v19, v17, s9
    v_perm_b32 v61, v23, v21, s9
    v_perm_b32 v62, v27, v25, s9
    v_perm_b32 v63, v31, v29, s9
    v_perm_b32 v64, v34, v32, s8
    v_perm_b32 v65, v38, v36, s8
    v_perm_b32 v66, v42, v40, s8
    v_perm_b32 v67, v46, v44, s8
    v_perm_b32 v68, v34, v32, s9
    v_perm_b32 v69, v38, v36, s9
    v_perm_b32 v70, v42, v40, s9
    v_perm_b32 v71, v46, v44, s9
    v_perm_b32 v72, v35, v33, s8
    v_perm_b32 v73, v39, v37, s8
    v_perm_b32 v74, v43, v41, s8
    v_perm_b32 v75, v47, v45, s8
    v_perm_b32 v76, v35, v33, s9
    v_perm_b32 v77, v39, v37, s9
    v_perm_b32 v78, v43, v41, s9
    v_perm_b32 v79, v47, v45, s9
    s_barrier
Lpoll_4:
    buffer_load_dwordx4 v[232:235], v8, s[44:47], s68 offen offset:2048 sc1
    buffer_load_dwordx4 v[236:239], v8, s[44:47], s69 offen offset:2048 sc1
    buffer_load_dwordx4 v[240:243], v8, s[44:47], s68 offen sc1
    buffer_load_dwordx4 v[244:247], v8, s[44:47], s69 offen sc1
    s_waitcnt vmcnt(0)
    v_xor_b32 v80, s97, v232
    v_xor_b32 v81, s97, v233
    v_xor_b32 v82, s97, v234
    v_xor_b32 v83, s97, v235
    v_xor_b32 v84, s97, v236
    v_xor_b32 v85, s97, v237
    v_xor_b32 v86, s97, v238
    v_xor_b32 v87, s97, v239
    v_xor_b32 v88, s97, v240
    v_xor_b32 v89, s97, v241
    v_xor_b32 v90, s97, v242
    v_xor_b32 v91, s97, v243
    v_xor_b32 v92, s97, v244
    v_xor_b32 v93, s97, v245
    v_xor_b32 v94, s97, v246
    v_xor_b32 v95, s97, v247
    v_or3_b32 v11, v80, v81, v82
    v_or3_b32 v11, v83, v84, v11
    v_or3_b32 v11, v85, v86, v11
    v_or3_b32 v11, v87, v88, v11
    v_or3_b32 v11, v89, v90, v11
    v_or3_b32 v11, v91, v92, v11
    v_or3_b32 v11, v93, v94, v11
    v_or_b32 v11, v95, v11
    v_and_b32 v11, 3, v11
    v_cmp_ne_u32 vcc, 0, v11
    s_cbranch_vccz Lgot_5
    s_sub_u32 s7, s7, 1
    s_cbranch_scc0 Lpoll_4
    s_branch L_exit
Lgot_5:
    v_pk_add_f32 v[104:105], v[80:81], v[84:85]
    v_pk_add_f32 v[106:107], v[82:83], v[86:87]
    v_pk_add_f32 v[108:109], v[88:89], v[92:93]
    v_pk_add_f32 v[110:111], v[90:91], v[94:95]
    v_cvt_pk_bf16_f32 v80, v104, v105
    v_cvt_pk_bf16_f32 v81, v106, v107
    v_cvt_pk_bf16_f32 v82, v108, v109
    v_cvt_pk_bf16_f32 v83, v110, v111
    v_lshlrev_b32 v104, 16, v80
    v_and_b32 v105, s10, v80
    v_lshlrev_b32 v106, 16, v81
    v_and_b32 v107, s10, v81
    v_lshlrev_b32 v108, 16, v82
    v_and_b32 v109, s10, v82
    v_lshlrev_b32 v110, 16, v83
    v_and_b32 v111, s10, v83
    v_pk_add_f32 v[104:105], v[104:105], 1.0 op_sel_hi:[1,0]
    v_pk_add_f32 v[106:107], v[106:107], 1.0 op_sel_hi:[1,0]
    v_cvt_pk_bf16_f32 v10, v104, v105
    v_cvt_pk_bf16_f32 v11, v106, v107
    v_lshlrev_b32 v104, 16, v10
    v_and_b32 v105, s10, v10
    v_lshlrev_b32 v106, 16, v11
    v_and_b32 v107, s10, v11
    v_pk_mul_f32 v[104:105], v[104:105], v[98:99]
    v_pk_mul_f32 v[106:107], v[106:107], v[100:101]
    v_cvt_pk_bf16_f32 v10, v104, v105
    v_cvt_pk_bf16_f32 v11, v106, v107
    v_lshlrev_b32 v104, 16, v10
    v_and_b32 v105, s10, v10
    v_lshlrev_b32 v106, 16, v11
    v_and_b32 v107, s10, v11
    v_pk_add_f32 v[104:105], v[104:105], v[108:109]
    v_pk_add_f32 v[106:107], v[106:107], v[110:111]
    v_cvt_pk_bf16_f32 v80, v104, v105
    v_cvt_pk_bf16_f32 v81, v106, v107
    ds_write_b64 v9, v[80:81]
    ds_read_b128 v[88:91], v13
    ds_read_b128 v[92:95], v13 offset:256
    s_waitcnt lgkmcnt(0)
    v_mfma_f32_16x16x32_bf16 v[128:131], v[88:91], v[48:51], 0
    v_mfma_f32_16x16x32_bf16 v[132:135], v[88:91], v[52:55], 0
    v_mfma_f32_16x16x32_bf16 v[136:139], v[88:91], v[56:59], 0
    v_mfma_f32_16x16x32_bf16 v[140:143], v[88:91], v[60:63], 0
    v_mfma_f32_16x16x32_bf16 v[128:131], v[92:95], v[64:67], v[128:131]
    v_mfma_f32_16x16x32_bf16 v[132:135], v[92:95], v[68:71], v[132:135]
    v_mfma_f32_16x16x32_bf16 v[136:139], v[92:95], v[72:75], v[136:139]
    v_mfma_f32_16x16x32_bf16 v[140:143], v[92:95], v[76:79], v[140:143]
    s_nop 5
    ds_write2_b32 v14, v128, v132 offset0:0 offset1:1
    s_nop 0
    ds_write2_b32 v14, v136, v140 offset0:2 offset1:3
    s_waitcnt lgkmcnt(0)
    s_barrier
    s_cmp_ge_u32 s3, 2
    s_cbranch_scc1 L_B_wo
    ds_read_b64 v[80:81], v112 offset:4096
    ds_read_b64 v[82:83], v112 offset:5120
    ds_read_b64 v[84:85], v112 offset:6144
    ds_read_b64 v[86:87], v112 offset:7168
    ds_read_b64 v[88:89], v112 offset:8192
    ds_read_b64 v[90:91], v112 offset:9216
    ds_read_b64 v[92:93], v112 offset:10240
    ds_read_b64 v[94:95], v112 offset:11264
    s_waitcnt lgkmcnt(4)
    v_pk_add_f32 v[80:81], v[80:81], v[82:83]
    v_pk_add_f32 v[84:85], v[84:85], v[86:87]
    s_waitcnt lgkmcnt(0)
    v_pk_add_f32 v[88:89], v[88:89], v[90:91]
    v_pk_add_f32 v[92:93], v[92:93], v[94:95]
    v_pk_add_f32 v[80:81], v[80:81], v[84:85]
    v_pk_add_f32 v[88:89], v[88:89], v[92:93]
    v_pk_add_f32 v[80:81], v[80:81], v[88:89]
    v_cvt_pk_bf16_f32 v152, v80, v81
    s_add_u32 s66, s76, 2621440
    buffer_store_dwordx2 v[152:153], v113, s[44:47], s66 offen
    buffer_store_dwordx2 v[152:153], v113, s[44:47], s76 offen sc1
L_B_wo:
    s_barrier
    s_add_u32 m0, s75, 98304
    s_nop 0
    buffer_load_dwordx4 v118, s[52:55], s74 offen nt lds
    s_add_u32 m0, s75, 99328
    s_add_u32 s74, s74, 8192
    buffer_load_dwordx4 v118, s[52:55], s74 offen nt lds
    s_add_u32 m0, s75, 100352
    s_add_u32 s74, s74, 8192
    buffer_load_dwordx4 v118, s[52:55], s74 offen nt lds
    s_add_u32 m0, s75, 101376
    s_add_u32 s74, s74, 8192
    buffer_load_dwordx4 v118, s[52:55], s74 offen nt lds
    s_add_u32 m0, s75, 102400
    s_add_u32 s74, s74, 8192
    buffer_load_dwordx4 v118, s[52:55], s74 offen nt lds
    s_add_u32 m0, s75, 103424
    s_add_u32 s74, s74, 8192
    buffer_load_dwordx4 v118, s[52:55], s74 offen nt lds
    s_add_u32 m0, s75, 104448
    s_add_u32 s74, s74, 8192
    buffer_load_dwordx4 v118, s[52:55], s74 offen nt lds
    s_add_u32 m0, s75, 105472
    s_add_u32 s74, s74, 8192
    buffer_load_dwordx4 v118, s[52:55], s74 offen nt lds
    s_waitcnt vmcnt(0)
    ds_read_b64 v[16:17], v120 offset:32768
    ds_read_b64 v[18:19], v120 offset:33792
    ds_read_b64 v[20:21], v120 offset:34816
    ds_read_b64 v[22:23], v120 offset:35840
    ds_read_b64 v[24:25], v120 offset:32896
    ds_read_b64 v[26:27], v120 offset:33920
    ds_read_b64 v[28:29], v120 offset:34944
    ds_read_b64 v[30:31], v120 offset:35968
    ds_read_b64 v[32:33], v120 offset:36864
    ds_read_b64 v[34:35], v120 offset:37888
    ds_read_b64 v[36:37], v120 offset:38912
    ds_read_b64 v[38:39], v120 offset:39936
    ds_read_b64 v[40:41], v120 offset:36992
    ds_read_b64 v[42:43], v120 offset:38016
    ds_read_b64 v[44:45], v120 offset:39040
    ds_read_b64 v[46:47], v120 offset:40064
    s_waitcnt lgkmcnt(0)
    v_perm_b32 v48, v18, v16, s8
    v_perm_b32 v49, v22, v20, s8
    v_perm_b32 v50, v26, v24, s8
    v_perm_b32 v51, v30, v28, s8
    v_perm_b32 v52, v18, v16, s9
    v_perm_b32 v53, v22, v20, s9
    v_perm_b32 v54, v26, v24, s9
    v_perm_b32 v55, v30, v28, s9
    v_perm_b32 v56, v19, v17, s8
    v_perm_b32 v57, v23, v21, s8
    v_perm_b32 v58, v27, v25, s8
    v_perm_b32 v59, v31, v29, s8
    v_perm_b32 v60, v19, v17, s9
    v_perm_b32 v61, v23, v21, s9
    v_perm_b32 v62, v27, v25, s9
    v_perm_b32 v63, v31, v29, s9
    v_perm_b32 v64, v34, v32, s8
    v_perm_b32 v65, v38, v36, s8
    v_perm_b32 v66, v42, v40, s8
    v_perm_b32 v67, v46, v44, s8
    v_perm_b32 v68, v34, v32, s9
    v_perm_b32 v69, v38, v36, s9
    v_perm_b32 v70, v42, v40, s9
    v_perm_b32 v71, v46, v44, s9
    v_perm_b32 v72, v35, v33, s8
    v_perm_b32 v73, v39, v37, s8
    v_perm_b32 v74, v43, v41, s8
    v_perm_b32 v75, v47, v45, s8
    v_perm_b32 v76, v35, v33, s9
    v_perm_b32 v77, v39, v37, s9
    v_perm_b32 v78, v43, v41, s9
    v_perm_b32 v79, v47, v45, s9
    s_barrier
    s_or_b32 s7, s7, 15
Lpoll_6:
    s_and_b32 s66, s7, 15
    s_cselect_b32 s66, s98, 0
    s_add_u32 s64, s78, s66
    s_add_u32 s65, s77, s66
    buffer_load_dwordx4 v[224:227], v115, s[44:47], s64 offen sc1
    buffer_load_dwordx2 v[228:229], v114, s[44:47], s65 offen sc1
    s_waitcnt vmcnt(0)
    v_sad_u32 v11, v225, s6, 0
    v_sad_u32 v11, v227, s6, v11
    v_xor_b32 v80, s100, v228
    v_xor_b32 v81, s100, v229
    v_or_b32 v10, v80, v81
    v_and_b32 v10, 0xff, v10
    v_or_b32 v11, v11, v10
    v_cmp_ne_u32 vcc, 0, v11
    s_cbranch_vccz Lgot_7
    s_sub_u32 s7, s7, 1
    s_cbranch_scc0 Lpoll_6
    s_branch L_exit
Lgot_7:
    v_mov_b32 v88, v224
    v_mov_b32 v89, v88
    s_nop 1
    v_permlane16_swap_b32 v88, v89
    v_max_f32 v88, v88, v89
    v_mov_b32 v89, v88
    s_nop 1
    v_permlane32_swap_b32 v88, v89
    v_max_f32 v88, v88, v89
    v_sub_f32 v88, v224, v88
    v_exp_f32 v88, v88
    s_nop 0
    v_mul_f32 v86, v226, v88
    v_mul_f32 v80, v80, v88
    v_mul_f32 v81, v81, v88
    v_mov_b32 v87, v86
    s_nop 0
    v_permlane32_swap_b32 v80, v81
    v_permlane32_swap_b32 v86, v87
    v_add_f32 v80, v80, v81
    v_add_f32 v86, v86, v87
    s_nop 1
    v_permlane16_swap_b32 v80, v86
    v_add_f32 v80, v80, v86
    v_rcp_f32 v81, v80
    v_mov_b32 v82, v80
    v_mov_b32 v83, v81
    s_nop 0
    v_permlane32_swap_b32 v80, v82
    v_permlane16_swap_b32 v81, v83
    v_mul_f32 v80, v80, v83
    v_mul_f32 v82, v82, v83
    v_cvt_pk_bf16_f32 v80, v80, v82
    s_mov_b64 s[60:61], exec
    s_and_b64 exec, exec, 0xffff
    ds_write_b32 v116, v80 offset:12288
    s_mov_b64 exec, s[60:61]
    s_waitcnt lgkmcnt(0)
    s_barrier
    ds_read_b128 v[88:91], v12 offset:12288
    ds_read_b128 v[92:95], v12 offset:12544
    s_waitcnt lgkmcnt(0)
    v_mfma_f32_16x16x32_bf16 v[128:131], v[88:91], v[48:51], 0
    v_mfma_f32_16x16x32_bf16 v[132:135], v[88:91], v[52:55], 0
    v_mfma_f32_16x16x32_bf16 v[136:139], v[88:91], v[56:59], 0
    v_mfma_f32_16x16x32_bf16 v[140:143], v[88:91], v[60:63], 0
    v_mfma_f32_16x16x32_bf16 v[128:131], v[92:95], v[64:67], v[128:131]
    v_mfma_f32_16x16x32_bf16 v[132:135], v[92:95], v[68:71], v[132:135]
    v_mfma_f32_16x16x32_bf16 v[136:139], v[92:95], v[72:75], v[136:139]
    v_mfma_f32_16x16x32_bf16 v[140:143], v[92:95], v[76:79], v[140:143]
    s_nop 4
    v_and_or_b32 v144, v128, s101, v5
    v_and_or_b32 v145, v132, s101, v5
    v_and_or_b32 v146, v136, s101, v5
    v_and_or_b32 v147, v140, s101, v5
    buffer_store_dwordx4 v[144:147], v117, s[44:47], s79 offen sc1
    s_branch L_exit
L_roleD:
    s_mov_b32 s12, s5
    s_lshr_b32 s14, s12, 4
    s_lshl_b32 s15, s14, 8
    s_lshl_b32 s13, s3, 5
    s_add_u32 s15, s15, s13
    s_mul_i32 s15, s15, 6144
    s_and_b32 s13, s12, 15
    s_lshl_b32 s13, s13, 7
    s_add_u32 s15, s15, s13
    s_lshl_b32 s13, s3, 7
    v_lshlrev_b32 v10, 10, v3
    v_lshl_add_u32 v10, v2, 3, v10
    v_lshrrev_b32 v124, 3, v1
    v_and_b32 v125, 7, v1
    v_lshlrev_b32 v125, 4, v125
    s_movk_i32 s68, 6144
    v_mad_u32_u24 v7, v124, s68, v125
    s_lshl_b32 s78, s3, 12
    s_lshl_b32 s79, s3, 13
    s_waitcnt lgkmcnt(0)
    s_mov_b32 s44, s42
    s_mov_b32 s45, s43
    s_mov_b32 s46, 5242880
    s_mov_b32 s47, 0x00020000
    buffer_load_dword v4, off, s[44:47], 0 sc1
    s_mov_b32 s48, s34
    s_mov_b32 s49, s35
    s_mov_b32 s50, 4096
    s_mov_b32 s51, 0x00020000
    buffer_load_dwordx2 v[8:9], v10, s[48:51], s13 offen
    s_mov_b32 s52, s36
    s_mov_b32 s53, s37
    s_mov_b32 s54, 3145728
    s_mov_b32 s55, 0x00020000
    s_add_u32 m0, s78, 32768
    s_nop 0
    buffer_load_dwordx4 v7, s[52:55], s15 offen nt lds
    s_add_u32 m0, s78, 33792
    s_add_u32 s15, s15, 49152
    buffer_load_dwordx4 v7, s[52:55], s15 offen nt lds
    s_add_u32 m0, s78, 34816
    s_add_u32 s15, s15, 49152
    buffer_load_dwordx4 v7, s[52:55], s15 offen nt lds
    s_add_u32 m0, s78, 35840
    s_add_u32 s15, s15, 49152
    buffer_load_dwordx4 v7, s[52:55], s15 offen nt lds
    s_lshl_b32 s70, s3, 9
    v_lshrrev_b32 v10, 3, v2
    v_lshlrev_b32 v10, 8, v10
    v_lshl_add_u32 v10, v3, 6, v10
    v_and_b32 v11, 7, v2
    v_lshl_add_u32 v10, v11, 3, v10
    v_add_u32 v10, s70, v10
    v_lshrrev_b32 v11, 2, v2
    v_add_u32 v11, v11, v2
    v_and_b32 v11, 3, v11
    v_lshlrev_b32 v12, 6, v11
    v_lshl_add_u32 v12, v3, 4, v12
    v_add_u32 v11, s70, v12
    s_lshl_b32 s13, s14, 11
    s_lshl_b32 s68, s3, 8
    s_add_u32 s13, s13, s68
    v_add_u32 v13, s13, v12
    s_lshl_b32 s72, s3, 10
    s_add_u32 s72, s72, 4096
    v_lshlrev_b32 v112, 8, v3
    v_lshl_add_u32 v112, v2, 4, v112
    v_add_u32 v112, s72, v112
    v_lshlrev_b32 v113, 3, v0
    v_lshrrev_b32 v116, 5, v0
    v_and_b32 v115, 31, v0
    v_lshlrev_b32 v114, 12, v116
    v_lshl_add_u32 v114, v115, 3, v114
    v_mul_u32_u24 v116, 12288, v116
    v_lshl_add_u32 v122, v115, 3, v116
    s_lshl_b32 s71, s14, 14
    s_and_b32 s72, s12, 15
    s_lshl_b32 s72, s72, 8
    s_add_u32 s71, s71, s72
    s_add_u32 s71, s71, 524288
    s_lshl_b32 s72, s12, 8
    s_add_u32 s73, s72, 65536
    s_add_u32 s72, s72, 8192
    s_mul_i32 s74, s3, 393216
    s_lshl_b32 s13, s12, 7
    s_add_u32 s74, s74, s13
    s_add_u32 s74, s74, 2048
    v_lshlrev_b32 v127, 10, v3
    v_lshl_add_u32 v127, v2, 3, v127
    v_add_u32 v115, s78, v127
    v_add_u32 v127, s79, v127
    s_waitcnt vmcnt(4)
    v_readfirstlane_b32 s6, v4
    s_nop 3
    s_and_b32 s100, s6, 0xff
    s_add_u32 s100, s100, 1
    s_cmp_eq_u32 s100, 0x100
    s_cselect_b32 s100, 1, s100
    s_add_u32 s6, s6, 0x100
    s_andn2_b32 s6, s6, 0xff
    s_or_b32 s6, s6, s100
    v_mov_b32 v4, s6
    v_mov_b32 v5, s100
    s_and_b32 s97, s100, 3
    v_lshlrev_b32 v56, 16, v8
    v_and_b32 v57, s10, v8
    v_lshlrev_b32 v58, 16, v9
    v_and_b32 v59, s10, v9
    v_mul_f32 v60, 0xbfb8aa3b, v56
    v_mul_f32 v61, 0xbfb8aa3b, v57
    v_mul_f32 v62, 0xbfb8aa3b, v58
    v_mul_f32 v63, 0xbfb8aa3b, v59
    v_exp_f32 v60, v60
    v_exp_f32 v61, v61
    v_exp_f32 v62, v62
    v_exp_f32 v63, v63
    v_add_f32 v60, 1.0, v60
    v_min_f32 v60, 0x7f7fffff, v60
    v_add_f32 v61, 1.0, v61
    v_min_f32 v61, 0x7f7fffff, v61
    v_add_f32 v62, 1.0, v62
    v_min_f32 v62, 0x7f7fffff, v62
    v_add_f32 v63, 1.0, v63
    v_min_f32 v63, 0x7f7fffff, v63
    v_rcp_f32 v116, v60
    v_rcp_f32 v117, v61
    v_rcp_f32 v118, v62
    v_rcp_f32 v119, v63
    v_mul_f32 v120, v56, v116
    v_fma_f32 v121, -v120, v60, v56
    v_fma_f32 v56, v121, v116, v120
    v_mul_f32 v120, v57, v117
    v_fma_f32 v121, -v120, v61, v57
    v_fma_f32 v57, v121, v117, v120
    v_mul_f32 v120, v58, v118
    v_fma_f32 v121, -v120, v62, v58
    v_fma_f32 v58, v121, v118, v120
    v_mul_f32 v120, v59, v119
    v_fma_f32 v121, -v120, v63, v59
    v_fma_f32 v59, v121, v119, v120
    v_cvt_pk_bf16_f32 v8, v56, v57
    v_cvt_pk_bf16_f32 v9, v58, v59
    ds_write_b64 v10, v[8:9]
    v_and_b32 v146, 3, v5
    v_mov_b32 v145, v4
    s_waitcnt lgkmcnt(0)
    s_barrier
    ds_read_b128 v[56:59], v13
    ds_read_b128 v[48:51], v11
    ds_read_b128 v[52:55], v11 offset:256
    s_waitcnt vmcnt(0)
    ds_read_b64 v[16:17], v115 offset:32768
    ds_read_b64 v[18:19], v115 offset:32896
    ds_read_b64 v[20:21], v115 offset:33024
    ds_read_b64 v[22:23], v115 offset:33152
    ds_read_b64 v[24:25], v115 offset:33280
    ds_read_b64 v[26:27], v115 offset:33408
    ds_read_b64 v[28:29], v115 offset:33536
    ds_read_b64 v[30:31], v115 offset:33664
    s_waitcnt lgkmcnt(0)
    v_perm_b32 v32, v18, v16, s8
    v_perm_b32 v33, v22, v20, s8
    v_perm_b32 v34, v26, v24, s8
    v_perm_b32 v35, v30, v28, s8
    v_perm_b32 v36, v18, v16, s9
    v_perm_b32 v37, v22, v20, s9
    v_perm_b32 v38, v26, v24, s9
    v_perm_b32 v39, v30, v28, s9
    v_perm_b32 v40, v19, v17, s8
    v_perm_b32 v41, v23, v21, s8
    v_perm_b32 v42, v27, v25, s8
    v_perm_b32 v43, v31, v29, s8
    v_perm_b32 v44, v19, v17, s9
    v_perm_b32 v45, v23, v21, s9
    v_perm_b32 v46, v27, v25, s9
    v_perm_b32 v47, v31, v29, s9
    v_mfma_f32_16x16x32_bf16 v[128:131], v[56:59], v[32:35], 0
    v_mfma_f32_16x16x32_bf16 v[132:135], v[56:59], v[36:39], 0
    v_mfma_f32_16x16x32_bf16 v[136:139], v[56:59], v[40:43], 0
    v_mfma_f32_16x16x32_bf16 v[140:143], v[56:59], v[44:47], 0
    s_nop 5
    ds_write2_b32 v112, v128, v132 offset0:0 offset1:1
    s_nop 0
    ds_write2_b32 v112, v136, v140 offset0:2 offset1:3
    s_waitcnt lgkmcnt(0)
    s_barrier
    s_cmp_ge_u32 s3, 2
    s_cbranch_scc1 L_D_z
    ds_read_b64 v[128:129], v113 offset:4096
    ds_read_b64 v[130:131], v113 offset:5120
    ds_read_b64 v[132:133], v113 offset:6144
    ds_read_b64 v[134:135], v113 offset:7168
    ds_read_b64 v[136:137], v113 offset:8192
    ds_read_b64 v[138:139], v113 offset:9216
    ds_read_b64 v[140:141], v113 offset:10240
    ds_read_b64 v[142:143], v113 offset:11264
    s_waitcnt lgkmcnt(4)
    v_pk_add_f32 v[128:129], v[128:129], v[130:131]
    v_pk_add_f32 v[132:133], v[132:133], v[134:135]
    s_waitcnt lgkmcnt(0)
    v_pk_add_f32 v[136:137], v[136:137], v[138:139]
    v_pk_add_f32 v[140:141], v[140:141], v[142:143]
    v_pk_add_f32 v[128:129], v[128:129], v[132:133]
    v_pk_add_f32 v[136:137], v[136:137], v[140:141]
    v_pk_add_f32 v[128:129], v[128:129], v[136:137]
    v_and_or_b32 v128, v128, -4, v146
    v_and_or_b32 v129, v129, -4, v146
    buffer_store_dwordx2 v[128:129], v114, s[44:47], s71 offen sc1
L_D_z:
    s_barrier
    s_add_u32 m0, s79, 32768
    s_nop 0
    buffer_load_dwordx4 v7, s[52:55], s74 offen nt lds
    s_add_u32 m0, s79, 33792
    s_add_u32 s74, s74, 49152
    buffer_load_dwordx4 v7, s[52:55], s74 offen nt lds
    s_add_u32 m0, s79, 34816
    s_add_u32 s74, s74, 49152
    buffer_load_dwordx4 v7, s[52:55], s74 offen nt lds
    s_add_u32 m0, s79, 35840
    s_add_u32 s74, s74, 49152
    buffer_load_dwordx4 v7, s[52:55], s74 offen nt lds
    s_add_u32 m0, s79, 36864
    s_add_u32 s74, s74, 49152
    buffer_load_dwordx4 v7, s[52:55], s74 offen nt lds
    s_add_u32 m0, s79, 37888
    s_add_u32 s74, s74, 49152
    buffer_load_dwordx4 v7, s[52:55], s74 offen nt lds
    s_add_u32 m0, s79, 38912
    s_add_u32 s74, s74, 49152
    buffer_load_dwordx4 v7, s[52:55], s74 offen nt lds
    s_add_u32 m0, s79, 39936
    s_add_u32 s74, s74, 49152
    buffer_load_dwordx4 v7, s[52:55], s74 offen nt lds
    s_waitcnt vmcnt(0)
    ds_read_b64 v[16:17], v127 offset:32768
    ds_read_b64 v[18:19], v127 offset:32896
    ds_read_b64 v[20:21], v127 offset:33024
    ds_read_b64 v[22:23], v127 offset:33152
    ds_read_b64 v[24:25], v127 offset:33280
    ds_read_b64 v[26:27], v127 offset:33408
    ds_read_b64 v[28:29], v127 offset:33536
    ds_read_b64 v[30:31], v127 offset:33664
    ds_read_b64 v[32:33], v127 offset:36864
    ds_read_b64 v[34:35], v127 offset:36992
    ds_read_b64 v[36:37], v127 offset:37120
    ds_read_b64 v[38:39], v127 offset:37248
    ds_read_b64 v[40:41], v127 offset:37376
    ds_read_b64 v[42:43], v127 offset:37504
    ds_read_b64 v[44:45], v127 offset:37632
    ds_read_b64 v[46:47], v127 offset:37760
    s_waitcnt lgkmcnt(0)
    v_perm_b32 v160, v18, v16, s8
    v_perm_b32 v161, v22, v20, s8
    v_perm_b32 v162, v26, v24, s8
    v_perm_b32 v163, v30, v28, s8
    v_perm_b32 v164, v18, v16, s9
    v_perm_b32 v165, v22, v20, s9
    v_perm_b32 v166, v26, v24, s9
    v_perm_b32 v167, v30, v28, s9
    v_perm_b32 v168, v19, v17, s8
    v_perm_b32 v169, v23, v21, s8
    v_perm_b32 v170, v27, v25, s8
    v_perm_b32 v171, v31, v29, s8
    v_perm_b32 v172, v19, v17, s9
    v_perm_b32 v173, v23, v21, s9
    v_perm_b32 v174, v27, v25, s9
    v_perm_b32 v175, v31, v29, s9
    v_perm_b32 v176, v34, v32, s8
    v_perm_b32 v177, v38, v36, s8
    v_perm_b32 v178, v42, v40, s8
    v_perm_b32 v179, v46, v44, s8
    v_perm_b32 v180, v34, v32, s9
    v_perm_b32 v181, v38, v36, s9
    v_perm_b32 v182, v42, v40, s9
    v_perm_b32 v183, v46, v44, s9
    v_perm_b32 v184, v35, v33, s8
    v_perm_b32 v185, v39, v37, s8
    v_perm_b32 v186, v43, v41, s8
    v_perm_b32 v187, v47, v45, s8
    v_perm_b32 v188, v35, v33, s9
    v_perm_b32 v189, v39, v37, s9
    v_perm_b32 v190, v43, v41, s9
    v_perm_b32 v191, v47, v45, s9
    v_mfma_f32_16x16x32_bf16 v[128:131], v[48:51], v[160:163], 0
    v_mfma_f32_16x16x32_bf16 v[132:135], v[48:51], v[164:167], 0
    v_mfma_f32_16x16x32_bf16 v[136:139], v[48:51], v[168:171], 0
    v_mfma_f32_16x16x32_bf16 v[140:143], v[48:51], v[172:175], 0
    v_mfma_f32_16x16x32_bf16 v[128:131], v[52:55], v[176:179], v[128:131]
    v_mfma_f32_16x16x32_bf16 v[132:135], v[52:55], v[180:183], v[132:135]
    v_mfma_f32_16x16x32_bf16 v[136:139], v[52:55], v[184:187], v[136:139]
    v_mfma_f32_16x16x32_bf16 v[140:143], v[52:55], v[188:191], v[140:143]
    s_nop 5
    ds_write2_b32 v112, v128, v132 offset0:0 offset1:1
    s_nop 0
    ds_write2_b32 v112, v136, v140 offset0:2 offset1:3
    s_waitcnt lgkmcnt(0)
    s_barrier
    s_cmp_ge_u32 s3, 2
    s_cbranch_scc1 L_exit
    ds_read_b64 v[128:129], v113 offset:4096
    ds_read_b64 v[130:131], v113 offset:5120
    ds_read_b64 v[132:133], v113 offset:6144
    ds_read_b64 v[134:135], v113 offset:7168
    ds_read_b64 v[136:137], v113 offset:8192
    ds_read_b64 v[138:139], v113 offset:9216
    ds_read_b64 v[140:141], v113 offset:10240
    ds_read_b64 v[142:143], v113 offset:11264
    s_waitcnt lgkmcnt(4)
    v_pk_add_f32 v[128:129], v[128:129], v[130:131]
    v_pk_add_f32 v[132:133], v[132:133], v[134:135]
    s_waitcnt lgkmcnt(0)
    v_pk_add_f32 v[136:137], v[136:137], v[138:139]
    v_pk_add_f32 v[140:141], v[140:141], v[142:143]
    v_pk_add_f32 v[128:129], v[128:129], v[132:133]
    v_pk_add_f32 v[136:137], v[136:137], v[140:141]
    v_pk_add_f32 v[128:129], v[128:129], v[136:137]
    v_cvt_pk_bf16_f32 v144, v128, v129
    buffer_store_dwordx2 v[144:145], v122, s[44:47], s72 offen sc1
    s_branch L_exit
L_roleM:
    s_mov_b32 s12, s5
    v_lshrrev_b32 v124, 3, v1
    v_and_b32 v125, 7, v1
    v_lshlrev_b32 v8, 4, v125
    s_movk_i32 s14, 3584
    v_lshrrev_b32 v6, 1, v124
    v_xor_b32 v6, v6, v125
    v_lshlrev_b32 v6, 4, v6
    v_mad_u32_u24 v104, v124, s14, v6
    v_xor_b32 v105, 64, v104
    v_xor_b32 v106, 32, v104
    v_xor_b32 v107, 0x60, v104
    v_lshlrev_b32 v7, 13, v3
    v_lshl_add_u32 v7, v2, 3, v7
    s_mul_i32 s74, s3, 229376
    s_lshl_b32 s13, s12, 7
    s_add_u32 s74, s74, s13
    s_mov_b32 s75, s74
    s_lshl_b32 s13, s3, 7
    s_lshl_b32 s76, s12, 16
    s_add_u32 s76, s76, s13
    s_lshl_b32 s79, s3, 13
    s_lshl_b32 s71, s12, 1
    s_add_u32 s71, s71, s3
    s_and_b32 s71, s71, 63
    s_lshr_b32 s72, s71, 4
    s_and_b32 s73, s71, 15
    s_lshl_b32 s77, s72, 10
    s_lshl_b32 s78, s73, 6
    s_add_u32 s77, s77, s78
    v_and_b32 v9, 1, v3
    v_lshlrev_b32 v9, 1, v9
    v_lshrrev_b32 v10, 1, v3
    v_add_u32 v9, v9, v10
    v_lshl_add_u32 v9, v125, 2, v9
    v_lshlrev_b32 v10, 1, v9
    s_waitcnt lgkmcnt(0)
    s_mov_b32 s44, s42
    s_mov_b32 s45, s43
    s_mov_b32 s46, 5242880
    s_mov_b32 s47, 0x00020000
    buffer_load_dword v4, off, s[44:47], 0 sc1
    s_mov_b32 s56, s16
    s_mov_b32 s57, s17
    s_mov_b32 s58, 4096
    s_mov_b32 s59, 0x00020000
    buffer_load_ushort v126, v10, s[56:59], s77 offen
    v_lshlrev_b32 v11, 4, v0
    s_mov_b32 s64, 2785280
    buffer_load_dword v255, v11, s[44:47], s64 offen sc1
    v_lshrrev_b32 v11, 4, v0
    s_mov_b32 s64, 8448
    v_mul_lo_u32 v11, v11, s64
    v_lshl_add_u32 v11, v2, 4, v11
    s_lshl_b32 s64, s12, 8
    s_add_u32 s64, s64, 3276800
    buffer_load_dword v255, v11, s[44:47], s64 offen sc1
    s_waitcnt vmcnt(2)
    v_readfirstlane_b32 s6, v4
    s_nop 3
    s_and_b32 s100, s6, 0xff
    s_add_u32 s100, s100, 1
    s_cmp_eq_u32 s100, 0x100
    s_cselect_b32 s100, 1, s100
    s_add_u32 s6, s6, 0x100
    s_andn2_b32 s6, s6, 0xff
    s_or_b32 s6, s6, s100
    v_mov_b32 v4, s6
    v_mov_b32 v5, s100
    s_and_b32 s97, s100, 3
    s_getreg_b32 s99, hwreg(HW_REG_XCC_ID)
    s_and_b32 s99, s99, 15
    v_mov_b32 v121, s99
    s_cmp_lg_u32 s3, 0
    s_cbranch_scc1 Lxt_8
    v_mov_b32 v16, s99
    v_mov_b32 v17, v4
    s_lshl_b32 s13, s12, 3
    s_add_u32 s13, s13, 147456
    s_mov_b64 exec, 1
    buffer_store_dwordx2 v[16:17], off, s[44:47], s13 sc1
    s_mov_b64 exec, -1
Lxt_8:
    v_and_b32 v122, 31, v1
    v_lshlrev_b32 v122, 3, v122
    v_add_u32 v122, 147456, v122
    s_cmp_ge_u32 s12, 28
    s_cbranch_scc1 L_M_addr
    s_mov_b32 s56, s28
    s_mov_b32 s57, s29
    s_mov_b32 s58, 1835008
    s_mov_b32 s59, 0x00020000
    s_add_u32 m0, s79, 32768
    s_nop 0
    buffer_load_dwordx4 v104, s[56:59], s74 offen nt lds
    s_add_u32 m0, s79, 33792
    s_add_u32 s74, s74, 28672
    buffer_load_dwordx4 v105, s[56:59], s74 offen nt lds
    s_add_u32 m0, s79, 34816
    s_add_u32 s74, s74, 28672
    buffer_load_dwordx4 v104, s[56:59], s74 offen nt lds
    s_add_u32 m0, s79, 35840
    s_add_u32 s74, s74, 28672
    buffer_load_dwordx4 v105, s[56:59], s74 offen nt lds
    s_add_u32 m0, s79, 36864
    s_add_u32 s74, s74, 28672
    buffer_load_dwordx4 v104, s[56:59], s74 offen nt lds
    s_add_u32 m0, s79, 37888
    s_add_u32 s74, s74, 28672
    buffer_load_dwordx4 v105, s[56:59], s74 offen nt lds
    s_add_u32 m0, s79, 38912
    s_add_u32 s74, s74, 28672
    buffer_load_dwordx4 v104, s[56:59], s74 offen nt lds
    s_add_u32 m0, s79, 39936
    s_add_u32 s74, s74, 28672
    buffer_load_dwordx4 v105, s[56:59], s74 offen nt lds
    s_mov_b32 s60, s30
    s_mov_b32 s61, s31
    s_mov_b32 s62, 1835008
    s_mov_b32 s63, 0x00020000
    s_add_u32 m0, s79, 98304
    s_nop 0
    buffer_load_dwordx4 v106, s[60:63], s75 offen nt lds
    s_add_u32 m0, s79, 99328
    s_add_u32 s75, s75, 28672
    buffer_load_dwordx4 v107, s[60:63], s75 offen nt lds
    s_add_u32 m0, s79, 100352
    s_add_u32 s75, s75, 28672
    buffer_load_dwordx4 v106, s[60:63], s75 offen nt lds
    s_add_u32 m0, s79, 101376
    s_add_u32 s75, s75, 28672
    buffer_load_dwordx4 v107, s[60:63], s75 offen nt lds
    s_add_u32 m0, s79, 102400
    s_add_u32 s75, s75, 28672
    buffer_load_dwordx4 v106, s[60:63], s75 offen nt lds
    s_add_u32 m0, s79, 103424
    s_add_u32 s75, s75, 28672
    buffer_load_dwordx4 v107, s[60:63], s75 offen nt lds
    s_add_u32 m0, s79, 104448
    s_add_u32 s75, s75, 28672
    buffer_load_dwordx4 v106, s[60:63], s75 offen nt lds
    s_add_u32 m0, s79, 105472
    s_add_u32 s75, s75, 28672
    buffer_load_dwordx4 v107, s[60:63], s75 offen nt lds
    s_mov_b32 s52, s32
    s_mov_b32 s53, s33
    s_mov_b32 s54, 1835008
    s_mov_b32 s55, 0x00020000
    buffer_load_dwordx2 v[64:65], v7, s[52:55], s76 offen nt
    s_add_u32 s76, s76, 1024
    buffer_load_dwordx2 v[66:67], v7, s[52:55], s76 offen nt
    s_add_u32 s76, s76, 1024
    buffer_load_dwordx2 v[68:69], v7, s[52:55], s76 offen nt
    s_add_u32 s76, s76, 1024
    buffer_load_dwordx2 v[70:71], v7, s[52:55], s76 offen nt
    s_add_u32 s76, s76, 1024
    buffer_load_dwordx2 v[72:73], v7, s[52:55], s76 offen nt
    s_add_u32 s76, s76, 1024
    buffer_load_dwordx2 v[74:75], v7, s[52:55], s76 offen nt
    s_add_u32 s76, s76, 1024
    buffer_load_dwordx2 v[76:77], v7, s[52:55], s76 offen nt
    s_add_u32 s76, s76, 1024
    buffer_load_dwordx2 v[78:79], v7, s[52:55], s76 offen nt
    s_add_u32 s76, s76, 25600
    buffer_load_dwordx2 v[80:81], v7, s[52:55], s76 offen nt
    s_add_u32 s76, s76, 1024
    buffer_load_dwordx2 v[82:83], v7, s[52:55], s76 offen nt
    s_add_u32 s76, s76, 1024
    buffer_load_dwordx2 v[84:85], v7, s[52:55], s76 offen nt
    s_add_u32 s76, s76, 1024
    buffer_load_dwordx2 v[86:87], v7, s[52:55], s76 offen nt
    s_add_u32 s76, s76, 1024
    buffer_load_dwordx2 v[88:89], v7, s[52:55], s76 offen nt
    s_add_u32 s76, s76, 1024
    buffer_load_dwordx2 v[90:91], v7, s[52:55], s76 offen nt
    s_add_u32 s76, s76, 1024
    buffer_load_dwordx2 v[92:93], v7, s[52:55], s76 offen nt
    s_add_u32 s76, s76, 1024
    buffer_load_dwordx2 v[94:95], v7, s[52:55], s76 offen nt
L_M_addr:
    v_lshrrev_b32 v111, 1, v9
    v_lshlrev_b32 v111, 3, v111
    v_and_b32 v110, 1, v9
    v_lshlrev_b32 v110, 4, v110
    v_lshl_add_u32 v113, v3, 3, v8
    v_lshrrev_b32 v114, 1, v113
    s_mov_b32 s13, 8448
    v_mul_lo_u32 v123, v124, s13
    v_add_u32 v123, v123, v8
    s_lshl_b32 s78, s72, 11
    s_lshl_b32 s13, s73, 7
    s_add_u32 s78, s78, s13
    v_add_u32 v123, s78, v123
    s_add_u32 s78, s78, 163840
    s_mul_i32 s74, s72, 12288
    s_add_u32 s74, s74, s13
    s_add_u32 s74, s74, 8192
    s_add_u32 s75, s74, 6144
    v_mov_b32 v109, v4
    v_lshrrev_b32 v11, 2, v2
    v_add_u32 v11, v11, v2
    v_and_b32 v11, 3, v11
    v_lshlrev_b32 v12, 6, v11
    v_lshl_add_u32 v12, v3, 4, v12
    s_and_b32 s13, s3, 3
    s_lshr_b32 s14, s3, 2
    s_mul_i32 s15, s13, 12288
    s_lshl_b32 s68, s14, 4
    s_add_u32 s15, s15, s68
    s_add_u32 s72, s15, 12288
    s_add_u32 s73, s15, 10240
    v_lshlrev_b32 v15, 5, v1
    s_lshl_b32 s68, s13, 11
    s_add_u32 s68, s68, 163840
    s_lshl_b32 s69, s14, 4
    s_sub_u32 s99, 16, s69
    s_add_u32 s69, s69, s68
    s_add_u32 s99, s99, s68
    s_mul_i32 s15, s13, 1088
    s_lshl_b32 s70, s14, 3
    s_add_u32 s15, s15, s70
    v_lshlrev_b32 v115, 4, v1
    v_add_u32 v115, s15, v115
    v_lshrrev_b32 v116, 6, v12
    v_mul_u32_u24 v116, 1088, v116
    v_lshl_add_u32 v116, v3, 4, v116
    v_lshrrev_b32 v8, 2, v2
    v_lshrrev_b32 v9, 3, v2
    v_and_b32 v10, 1, v3
    v_lshl_or_b32 v9, v10, 2, v9
    v_and_b32 v10, 2, v1
    v_xor_b32 v9, v9, v10
    v_xor_b32 v9, s3, v9
    v_lshlrev_b32 v9, 4, v9
    v_lshl_add_u32 v9, v10, 15, v9
    v_lshl_add_u32 v8, v3, 3, v8
    v_lshl_add_u32 v9, v8, 7, v9
    v_and_b32 v10, 1, v1
    v_lshl_add_u32 v9, v10, 3, v9
    v_add_u32 v8, 32768, v9
    v_xor_b32 v9, 32, v8
    s_lshl_b32 s70, s14, 8
    s_lshl_b32 s15, s13, 4
    s_add_u32 s70, s70, s15
    v_lshlrev_b32 v13, 6, v3
    v_lshl_add_u32 v13, v2, 1, v13
    v_add_u32 v13, s70, v13
    s_mul_i32 s70, s12, 8448
    s_lshl_b32 s15, s3, 8
    s_add_u32 s70, s70, s15
    s_add_u32 s70, s70, 655360
    v_lshlrev_b32 v14, 11, v3
    v_lshl_add_u32 v14, v2, 4, v14
    s_cmp_ge_u32 s12, 28
    s_cbranch_scc1 L_M_red
    s_waitcnt vmcnt(16)
    s_barrier
    ds_read_b64_tr_b16 v[128:129], v8 offset:0
    ds_read_b64_tr_b16 v[130:131], v9 offset:512
    ds_read_b64_tr_b16 v[132:133], v8 offset:4096
    ds_read_b64_tr_b16 v[134:135], v9 offset:4608
    ds_read_b64_tr_b16 v[136:137], v8 offset:8192
    ds_read_b64_tr_b16 v[138:139], v9 offset:8704
    ds_read_b64_tr_b16 v[140:141], v8 offset:12288
    ds_read_b64_tr_b16 v[142:143], v9 offset:12800
    ds_read_b64_tr_b16 v[144:145], v8 offset:16384
    ds_read_b64_tr_b16 v[146:147], v9 offset:16896
    ds_read_b64_tr_b16 v[148:149], v8 offset:20480
    ds_read_b64_tr_b16 v[150:151], v9 offset:20992
    ds_read_b64_tr_b16 v[152:153], v8 offset:24576
    ds_read_b64_tr_b16 v[154:155], v9 offset:25088
    ds_read_b64_tr_b16 v[156:157], v8 offset:28672
    ds_read_b64_tr_b16 v[158:159], v9 offset:29184
    ds_read_b64_tr_b16 v[160:161], v8 offset:32768
    ds_read_b64_tr_b16 v[162:163], v9 offset:33280
    ds_read_b64_tr_b16 v[164:165], v8 offset:36864
    ds_read_b64_tr_b16 v[166:167], v9 offset:37376
    ds_read_b64_tr_b16 v[168:169], v8 offset:40960
    ds_read_b64_tr_b16 v[170:171], v9 offset:41472
    ds_read_b64_tr_b16 v[172:173], v8 offset:45056
    ds_read_b64_tr_b16 v[174:175], v9 offset:45568
    ds_read_b64_tr_b16 v[176:177], v8 offset:49152
    ds_read_b64_tr_b16 v[178:179], v9 offset:49664
    ds_read_b64_tr_b16 v[180:181], v8 offset:53248
    ds_read_b64_tr_b16 v[182:183], v9 offset:53760
    ds_read_b64_tr_b16 v[184:185], v8 offset:57344
    ds_read_b64_tr_b16 v[186:187], v9 offset:57856
    ds_read_b64_tr_b16 v[188:189], v8 offset:61440
    ds_read_b64_tr_b16 v[190:191], v9 offset:61952
    s_waitcnt vmcnt(0)
    v_perm_b32 v192, v66, v64, s8
    v_perm_b32 v193, v70, v68, s8
    v_perm_b32 v194, v74, v72, s8
    v_perm_b32 v195, v78, v76, s8
    v_perm_b32 v196, v66, v64, s9
    v_perm_b32 v197, v70, v68, s9
    v_perm_b32 v198, v74, v72, s9
    v_perm_b32 v199, v78, v76, s9
    v_perm_b32 v200, v67, v65, s8
    v_perm_b32 v201, v71, v69, s8
    v_perm_b32 v202, v75, v73, s8
    v_perm_b32 v203, v79, v77, s8
    v_perm_b32 v204, v67, v65, s9
    v_perm_b32 v205, v71, v69, s9
    v_perm_b32 v206, v75, v73, s9
    v_perm_b32 v207, v79, v77, s9
    v_perm_b32 v208, v82, v80, s8
    v_perm_b32 v209, v86, v84, s8
    v_perm_b32 v210, v90, v88, s8
    v_perm_b32 v211, v94, v92, s8
    v_perm_b32 v212, v82, v80, s9
    v_perm_b32 v213, v86, v84, s9
    v_perm_b32 v214, v90, v88, s9
    v_perm_b32 v215, v94, v92, s9
    v_perm_b32 v216, v83, v81, s8
    v_perm_b32 v217, v87, v85, s8
    v_perm_b32 v218, v91, v89, s8
    v_perm_b32 v219, v95, v93, s8
    v_perm_b32 v220, v83, v81, s9
    v_perm_b32 v221, v87, v85, s9
    v_perm_b32 v222, v91, v89, s9
    v_perm_b32 v223, v95, v93, s9
    s_waitcnt lgkmcnt(0)
    s_barrier
L_M_red:
    s_mov_b32 s56, s38
    s_mov_b32 s57, s39
    s_mov_b32 s58, 4096
    s_mov_b32 s59, 0x00020000
    s_cmp_ge_u32 s3, 2
    s_cbranch_scc1 L_M_x1
    v_lshlrev_b32 v118, 16, v126
    s_mov_b32 s48, 1048576
    s_mov_b32 s49, 1116160
    s_mov_b32 s50, 1183744
    s_mov_b32 s51, 1251328
    s_mov_b32 s52, 1318912
    s_mov_b32 s53, 1386496
    s_mov_b32 s54, 1454080
    s_mov_b32 s55, 1521664
Lpoll_9:
    buffer_load_dwordx2 v[100:101], v111, s[44:47], s74 offen sc1
    buffer_load_dwordx2 v[104:105], v122, s[44:47], 0 offen sc1
    buffer_load_dwordx2 v[102:103], v111, s[44:47], s75 offen sc1
    buffer_load_dwordx4 v[232:235], v15, s[44:47], s72 offen sc1
    buffer_load_dwordx4 v[236:239], v15, s[44:47], s73 offen sc1
    s_waitcnt vmcnt(0)
    v_sad_u32 v11, v101, s6, 0
    v_sad_u32 v11, v105, s6, v11
    v_sad_u32 v11, v103, s6, v11
    v_sad_u32 v11, v233, s6, v11
    v_sad_u32 v11, v235, s6, v11
    v_sad_u32 v11, v237, s6, v11
    v_sad_u32 v11, v239, s6, v11
    v_cmp_ne_u32 vcc, 0, v11
    s_cbranch_vccz Lgot_10
    s_sleep 1
    s_sub_u32 s7, s7, 1
    s_cbranch_scc0 Lpoll_9
    s_branch L_exit
Lgot_10:
    v_cmp_ne_u32 vcc, v104, v121
    s_cmp_eq_u64 vcc, 0
    s_cselect_b32 s98, 2621440, 0
    s_add_u32 s78, s78, s98
    buffer_load_dwordx4 v[64:67], v123, s[44:47], s48 offen sc1
    buffer_load_dwordx4 v[68:71], v123, s[44:47], s49 offen sc1
    buffer_load_dwordx4 v[72:75], v123, s[44:47], s50 offen sc1
    buffer_load_dwordx4 v[76:79], v123, s[44:47], s51 offen sc1
    buffer_load_dwordx4 v[80:83], v123, s[44:47], s52 offen sc1
    buffer_load_dwordx4 v[84:87], v123, s[44:47], s53 offen sc1
    buffer_load_dwordx4 v[88:91], v123, s[44:47], s54 offen sc1
    buffer_load_dwordx4 v[92:95], v123, s[44:47], s55 offen sc1
    s_sleep 2
Lpoll_11:
    buffer_load_dwordx4 v[64:67], v123, s[44:47], s48 offen sc1
    buffer_load_dwordx4 v[68:71], v123, s[44:47], s49 offen sc1
    buffer_load_dwordx4 v[72:75], v123, s[44:47], s50 offen sc1
    buffer_load_dwordx4 v[76:79], v123, s[44:47], s51 offen sc1
    buffer_load_dwordx4 v[80:83], v123, s[44:47], s52 offen sc1
    buffer_load_dwordx4 v[84:87], v123, s[44:47], s53 offen sc1
    buffer_load_dwordx4 v[88:91], v123, s[44:47], s54 offen sc1
    buffer_load_dwordx4 v[92:95], v123, s[44:47], s55 offen sc1
    s_waitcnt vmcnt(8)
    v_xor_b32 v16, s100, v64
    v_xor_b32 v17, s100, v65
    v_xor_b32 v18, s100, v66
    v_xor_b32 v19, s100, v67
    v_xor_b32 v20, s100, v68
    v_xor_b32 v21, s100, v69
    v_xor_b32 v22, s100, v70
    v_xor_b32 v23, s100, v71
    v_xor_b32 v24, s100, v72
    v_xor_b32 v25, s100, v73
    v_xor_b32 v26, s100, v74
    v_xor_b32 v27, s100, v75
    v_xor_b32 v28, s100, v76
    v_xor_b32 v29, s100, v77
    v_xor_b32 v30, s100, v78
    v_xor_b32 v31, s100, v79
    v_xor_b32 v32, s100, v80
    v_xor_b32 v33, s100, v81
    v_xor_b32 v34, s100, v82
    v_xor_b32 v35, s100, v83
    v_xor_b32 v36, s100, v84
    v_xor_b32 v37, s100, v85
    v_xor_b32 v38, s100, v86
    v_xor_b32 v39, s100, v87
    v_xor_b32 v40, s100, v88
    v_xor_b32 v41, s100, v89
    v_xor_b32 v42, s100, v90
    v_xor_b32 v43, s100, v91
    v_xor_b32 v44, s100, v92
    v_xor_b32 v45, s100, v93
    v_xor_b32 v46, s100, v94
    v_xor_b32 v47, s100, v95
    v_or3_b32 v11, v16, v17, v18
    v_or3_b32 v11, v19, v20, v11
    v_or3_b32 v11, v21, v22, v11
    v_or3_b32 v11, v23, v24, v11
    v_or3_b32 v11, v25, v26, v11
    v_or3_b32 v11, v27, v28, v11
    v_or3_b32 v11, v29, v30, v11
    v_or3_b32 v11, v31, v32, v11
    v_or3_b32 v11, v33, v34, v11
    v_or3_b32 v11, v35, v36, v11
    v_or3_b32 v11, v37, v38, v11
    v_or3_b32 v11, v39, v40, v11
    v_or3_b32 v11, v41, v42, v11
    v_or3_b32 v11, v43, v44, v11
    v_or3_b32 v11, v45, v46, v11
    v_or_b32 v11, v47, v11
    v_and_b32 v11, 0xff, v11
    v_cmp_ne_u32 vcc, 0, v11
    s_cbranch_vccz Lgot_12
    s_sub_u32 s7, s7, 1
    s_cbranch_scc0 Lpoll_11
    s_branch L_exit
Lgot_12:
    v_lshrrev_b32 v119, v110, v100
    v_lshlrev_b32 v119, 16, v119
    v_pk_add_f32 v[16:17], v[16:17], v[20:21]
    v_pk_add_f32 v[18:19], v[18:19], v[22:23]
    v_pk_add_f32 v[20:21], v[24:25], v[28:29]
    v_pk_add_f32 v[22:23], v[26:27], v[30:31]
    v_pk_add_f32 v[24:25], v[32:33], v[36:37]
    v_pk_add_f32 v[26:27], v[34:35], v[38:39]
    v_pk_add_f32 v[28:29], v[40:41], v[44:45]
    v_pk_add_f32 v[30:31], v[42:43], v[46:47]
    v_pk_add_f32 v[16:17], v[16:17], v[24:25]
    v_pk_add_f32 v[18:19], v[18:19], v[26:27]
    v_pk_add_f32 v[20:21], v[20:21], v[28:29]
    v_pk_add_f32 v[22:23], v[22:23], v[30:31]
    v_pk_add_f32 v[16:17], v[16:17], v[20:21]
    v_pk_add_f32 v[18:19], v[18:19], v[22:23]
    s_nop 0
    v_permlane32_swap_b32 v16, v17
    v_permlane32_swap_b32 v18, v19
    v_add_f32 v16, v16, v17
    v_add_f32 v18, v18, v19
    s_nop 1
    v_permlane16_swap_b32 v16, v18
    v_add_f32 v16, v16, v18
    s_nop 1
    v_add_f32_dpp v16, v16, v16 row_ror:8 row_mask:0xf bank_mask:0xf
    v_cvt_pk_bf16_f32 v16, v16, v16
    v_lshlrev_b32 v16, 16, v16
    v_mul_f32 v16, v16, v119
    v_cvt_pk_bf16_f32 v16, v16, v16
    v_lshlrev_b32 v16, 16, v16
    v_add_f32 v118, v16, v118
    v_mov_b32 v16, v118
    v_mov_b32 v17, v118
    s_nop 1
    v_permlane32_swap_b32 v16, v17
    v_cvt_pk_bf16_f32 v108, v16, v17
    s_mov_b64 exec, 0x00ff00ff
    s_cmp_eq_u32 s98, 0
    s_cbranch_scc1 Lps_13
    buffer_store_dwordx2 v[108:109], v113, s[44:47], s78 offen
    s_branch Lps_14
Lps_13:
    buffer_store_dwordx2 v[108:109], v113, s[44:47], s78 offen sc1
Lps_14:
    s_mov_b64 exec, -1
    v_cvt_pk_bf16_f32 v118, v118, v118
    v_lshlrev_b32 v118, 16, v118
    v_lshrrev_b32 v120, v110, v102
    v_lshlrev_b32 v120, 16, v120
L_M_x1:
    s_cmp_lt_u32 s12, 28
    s_cbranch_scc1 Lmx_15
    s_cmp_ge_u32 s3, 2
    s_cbranch_scc1 L_exit
    s_waitcnt vmcnt(0)
    s_mov_b32 s50, 0
    s_mov_b32 s51, -1
    s_add_u32 s48, s98, 655360
    v_add_u32 v96, 0, v123
    v_add_u32 v97, 67584, v123
    v_add_u32 v98, 135168, v123
    v_add_u32 v99, 202752, v123
    v_mov_b32 v64, 0
    v_mov_b32 v65, 0
    v_mov_b32 v66, 0
    v_mov_b32 v67, 0
    v_mov_b32 v68, 0
    v_mov_b32 v69, 0
    v_mov_b32 v70, 0
    v_mov_b32 v71, 0
    v_mov_b32 v72, 0
    v_mov_b32 v73, 0
    v_mov_b32 v74, 0
    v_mov_b32 v75, 0
    v_cndmask_b32 v76, 0, v5, s[50:51]
    v_cndmask_b32 v77, 0, v5, s[50:51]
    v_cndmask_b32 v78, 0, v5, s[50:51]
    v_cndmask_b32 v79, 0, v5, s[50:51]
    s_branch L_M_fin
Lmx_15:
    s_cmp_lt_u32 s3, 2
    s_cbranch_scc1 Lcb_16
Lpoll_17:
    buffer_load_dwordx4 v[232:235], v15, s[44:47], s72 offen sc1
    buffer_load_dwordx4 v[236:239], v15, s[44:47], s73 offen sc1
    buffer_load_dwordx2 v[104:105], v122, s[44:47], 0 offen sc1
    s_waitcnt vmcnt(0)
    v_sad_u32 v11, v233, s6, 0
    v_sad_u32 v11, v235, s6, v11
    v_sad_u32 v11, v237, s6, v11
    v_sad_u32 v11, v239, s6, v11
    v_sad_u32 v11, v105, s6, v11
    v_cmp_ne_u32 vcc, 0, v11
    s_cbranch_vccz Lgot_18
    s_sleep 1
    s_sub_u32 s7, s7, 1
    s_cbranch_scc0 Lpoll_17
    s_branch L_exit
Lgot_18:
    v_cmp_ne_u32 vcc, v104, v121
    s_cmp_eq_u64 vcc, 0
    s_cselect_b32 s98, 2621440, 0
Lcb_16:
    s_add_u32 s69, s69, s98
    s_add_u32 s99, s99, s98
    s_add_u32 s70, s70, s98
    v_lshlrev_b32 v40, 16, v232
    v_and_b32 v41, s10, v232
    v_lshlrev_b32 v42, 16, v234
    v_and_b32 v43, s10, v234
    v_add_f32 v40, 1.0, v40
    v_add_f32 v41, 1.0, v41
    v_add_f32 v42, 1.0, v42
    v_add_f32 v43, 1.0, v43
    v_cvt_pk_bf16_f32 v10, v40, v41
    v_cvt_pk_bf16_f32 v11, v42, v43
    v_lshlrev_b32 v40, 16, v10
    v_and_b32 v41, s10, v10
    v_lshlrev_b32 v42, 16, v11
    v_and_b32 v43, s10, v11
    v_lshlrev_b32 v44, 16, v236
    v_and_b32 v45, s10, v236
    v_lshlrev_b32 v46, 16, v238
    v_and_b32 v47, s10, v238
    s_barrier
    v_mov_b32 v32, 0
    v_mov_b32 v33, 0
Lpoll_19:
    buffer_load_dwordx4 v[224:227], v15, s[44:47], s69 offen sc1
    buffer_load_dwordx4 v[228:231], v15, s[44:47], s99 offen sc1
    s_waitcnt vmcnt(0)
    v_sad_u32 v11, v225, s6, 0
    v_sad_u32 v11, v227, s6, v11
    v_sad_u32 v11, v229, s6, v11
    v_sad_u32 v11, v231, s6, v11
    v_cmp_ne_u32 vcc, 0, v11
    s_cbranch_vccz Lgot_20
    s_sub_u32 s7, s7, 1
    s_cbranch_scc0 Lpoll_19
    s_branch L_exit
Lgot_20:
    v_dot2c_f32_bf16 v32, s11, v224
    v_dot2c_f32_bf16 v33, v224, v224
    v_dot2c_f32_bf16 v32, s11, v226
    v_dot2c_f32_bf16 v33, v226, v226
    v_dot2c_f32_bf16 v32, s11, v228
    v_dot2c_f32_bf16 v33, v228, v228
    v_dot2c_f32_bf16 v32, s11, v230
    v_dot2c_f32_bf16 v33, v230, v230
    v_lshlrev_b32 v34, 16, v224
    v_and_b32 v35, s10, v224
    v_lshlrev_b32 v36, 16, v226
    v_and_b32 v37, s10, v226
    v_add_f32_dpp v32, v32, v32 row_ror:8 row_mask:0xf bank_mask:0xf
    v_add_f32_dpp v33, v33, v33 row_ror:8 row_mask:0xf bank_mask:0xf
    s_nop 0
    v_add_f32_dpp v32, v32, v32 row_ror:4 row_mask:0xf bank_mask:0xf
    v_add_f32_dpp v33, v33, v33 row_ror:4 row_mask:0xf bank_mask:0xf
    s_nop 0
    v_add_f32_dpp v32, v32, v32 row_ror:2 row_mask:0xf bank_mask:0xf
    v_add_f32_dpp v33, v33, v33 row_ror:2 row_mask:0xf bank_mask:0xf
    s_nop 0
    v_add_f32_dpp v32, v32, v32 row_ror:1 row_mask:0xf bank_mask:0xf
    v_add_f32_dpp v33, v33, v33 row_ror:1 row_mask:0xf bank_mask:0xf
    s_nop 1
    v_permlane32_swap_b32 v32, v33
    v_add_f32 v32, v32, v33
    v_mov_b32 v33, v32
    s_nop 1
    v_permlane16_swap_b32 v32, v33
    v_add_f32 v32, v32, v33
    v_mov_b32 v33, v32
    s_nop 1
    v_permlane32_swap_b32 v32, v33
    v_mul_f32 v32, 0x3b000000, v32
    v_mul_f32 v33, 0x3b000000, v33
    v_fma_f32 v33, -v32, v32, v33
    v_max_f32 v33, 0, v33
    v_cvt_pk_bf16_f32 v10, v32, v33
    v_lshlrev_b32 v32, 16, v10
    v_and_b32 v33, s10, v10
    v_add_f32 v33, 0x3727c5ac, v33
    v_cvt_pk_bf16_f32 v10, v33, v33
    v_lshlrev_b32 v33, 16, v10
    v_sqrt_f32 v33, v33
    s_nop 0
    v_cvt_pk_bf16_f32 v10, v33, v33
    v_lshlrev_b32 v33, 16, v10
    v_rcp_f32 v33, v33
    s_nop 0
    v_pk_add_f32 v[34:35], v[34:35], v[32:33] op_sel_hi:[1,0] neg_lo:[0,1] neg_hi:[0,1]
    v_pk_add_f32 v[36:37], v[36:37], v[32:33] op_sel_hi:[1,0] neg_lo:[0,1] neg_hi:[0,1]
    v_pk_mul_f32 v[34:35], v[34:35], v[32:33] op_sel:[0,1] op_sel_hi:[1,1]
    v_pk_mul_f32 v[36:37], v[36:37], v[32:33] op_sel:[0,1] op_sel_hi:[1,1]
    v_pk_fma_f32 v[34:35], v[34:35], v[40:41], v[44:45]
    v_pk_fma_f32 v[36:37], v[36:37], v[42:43], v[46:47]
    v_cvt_pk_bf16_f32 v16, v34, v35
    v_cvt_pk_bf16_f32 v17, v36, v37
    ds_write_b64 v115, v[16:17] offset:0
    s_waitcnt lgkmcnt(0)
    s_barrier
    ds_read_b128 v[16:19], v116 offset:0
    ds_read_b128 v[20:23], v116 offset:64
    ds_read_b128 v[24:27], v116 offset:128
    ds_read_b128 v[28:31], v116 offset:192
    ds_read_b128 v[32:35], v116 offset:256
    s_cmp_lg_u32 s71, 2
    s_cbranch_scc1 Lep_21
    s_cmp_lg_u32 s12, 0
    s_cbranch_scc1 Lep_21
    s_mov_b64 exec, 1
    buffer_store_dword v4, off, s[44:47], 0 sc1
    s_mov_b64 exec, -1
Lep_21:
    s_mov_b32 s50, 0
    s_mov_b32 s51, -1
    ds_read_b128 v[36:39], v116 offset:320
    s_waitcnt lgkmcnt(5)
    v_mfma_f32_16x16x32_bf16 v[100:103], v[16:19], v[128:131], 0
    s_add_u32 s48, s98, 655360
    v_add_u32 v96, 0, v123
    ds_read_b128 v[40:43], v116 offset:384
    s_waitcnt lgkmcnt(5)
    v_mfma_f32_16x16x32_bf16 v[100:103], v[20:23], v[132:135], v[100:103]
    v_add_u32 v97, 67584, v123
    v_add_u32 v98, 135168, v123
    ds_read_b128 v[44:47], v116 offset:448
    s_waitcnt lgkmcnt(5)
    v_mfma_f32_16x16x32_bf16 v[100:103], v[24:27], v[136:139], v[100:103]
    v_add_u32 v99, 202752, v123
    v_mov_b32 v64, 0
    ds_read_b128 v[48:51], v116 offset:512
    s_waitcnt lgkmcnt(5)
    v_mfma_f32_16x16x32_bf16 v[100:103], v[28:31], v[140:143], v[100:103]
    v_mov_b32 v65, 0
    v_mov_b32 v66, 0
    ds_read_b128 v[52:55], v116 offset:576
    s_waitcnt lgkmcnt(5)
    v_mfma_f32_16x16x32_bf16 v[100:103], v[32:35], v[144:147], v[100:103]
    v_mov_b32 v67, 0
    v_mov_b32 v68, 0
    ds_read_b128 v[56:59], v116 offset:640
    s_waitcnt lgkmcnt(5)
    v_mfma_f32_16x16x32_bf16 v[100:103], v[36:39], v[148:151], v[100:103]
    v_mov_b32 v69, 0
    v_mov_b32 v70, 0
    ds_read_b128 v[60:63], v116 offset:704
    s_waitcnt lgkmcnt(5)
    v_mfma_f32_16x16x32_bf16 v[100:103], v[40:43], v[152:155], v[100:103]
    v_mov_b32 v71, 0
    v_mov_b32 v72, 0
    ds_read_b128 v[240:243], v116 offset:768
    s_waitcnt lgkmcnt(5)
    v_mfma_f32_16x16x32_bf16 v[100:103], v[44:47], v[156:159], v[100:103]
    v_mov_b32 v73, 0
    v_mov_b32 v74, 0
    ds_read_b128 v[244:247], v116 offset:832
    s_waitcnt lgkmcnt(5)
    v_mfma_f32_16x16x32_bf16 v[100:103], v[48:51], v[160:163], v[100:103]
    v_mov_b32 v75, 0
    v_cndmask_b32 v76, 0, v5, s[50:51]
    ds_read_b128 v[248:251], v116 offset:896
    s_waitcnt lgkmcnt(5)
    v_mfma_f32_16x16x32_bf16 v[100:103], v[52:55], v[164:167], v[100:103]
    v_cndmask_b32 v77, 0, v5, s[50:51]
    v_cndmask_b32 v78, 0, v5, s[50:51]
    ds_read_b128 v[252:255], v116 offset:960
    s_waitcnt lgkmcnt(5)
    v_mfma_f32_16x16x32_bf16 v[100:103], v[56:59], v[168:171], v[100:103]
    v_cndmask_b32 v79, 0, v5, s[50:51]
    s_waitcnt lgkmcnt(4)
    v_mfma_f32_16x16x32_bf16 v[100:103], v[60:63], v[172:175], v[100:103]
    s_waitcnt lgkmcnt(3)
    v_mfma_f32_16x16x32_bf16 v[100:103], v[240:243], v[176:179], v[100:103]
    s_waitcnt lgkmcnt(2)
    v_mfma_f32_16x16x32_bf16 v[100:103], v[244:247], v[180:183], v[100:103]
    s_waitcnt lgkmcnt(1)
    v_mfma_f32_16x16x32_bf16 v[100:103], v[248:251], v[184:187], v[100:103]
    s_waitcnt lgkmcnt(0)
    v_mfma_f32_16x16x32_bf16 v[100:103], v[252:255], v[188:191], v[100:103]
    s_nop 7
    v_cvt_pk_bf16_f32 v16, v100, v100
    v_lshlrev_b32 v16, 16, v16
    s_nop 1
    v_mov_b32_dpp v17, v16 row_shl:8 row_mask:0xf bank_mask:0xf
    v_mul_f32 v18, 0xbfb8aa3b, v16
    v_exp_f32 v18, v18
    s_nop 0
    v_add_f32 v18, 1.0, v18
    v_rcp_f32 v18, v18
    s_nop 0
    v_mul_f32 v16, v16, v18
    v_cvt_pk_bf16_f32 v16, v16, v16
    v_lshlrev_b32 v16, 16, v16
    v_mul_f32 v16, v16, v17
    v_cvt_pk_bf16_f32 v16, v16, v16
    s_mov_b32 exec_lo, 0x00ff00ff
    s_mov_b32 exec_hi, 0x00ff00ff
    ds_write_b16 v13, v16 offset:21248
    s_mov_b64 exec, -1
    s_waitcnt lgkmcnt(0)
    s_barrier
    ds_read_b128 v[48:51], v12 offset:21248
    ds_read_b128 v[52:55], v12 offset:21504
    s_waitcnt lgkmcnt(0)
    v_mfma_f32_16x16x32_bf16 v[16:19], v[48:51], v[192:195], 0
    v_mfma_f32_16x16x32_bf16 v[20:23], v[48:51], v[196:199], 0
    v_mfma_f32_16x16x32_bf16 v[24:27], v[48:51], v[200:203], 0
    v_mfma_f32_16x16x32_bf16 v[28:31], v[48:51], v[204:207], 0
    v_mfma_f32_16x16x32_bf16 v[16:19], v[52:55], v[208:211], v[16:19]
    v_mfma_f32_16x16x32_bf16 v[20:23], v[52:55], v[212:215], v[20:23]
    v_mfma_f32_16x16x32_bf16 v[24:27], v[52:55], v[216:219], v[24:27]
    v_mfma_f32_16x16x32_bf16 v[28:31], v[52:55], v[220:223], v[28:31]
    s_nop 4
    v_and_or_b32 v56, v16, s101, v5
    v_and_or_b32 v57, v20, s101, v5
    v_and_or_b32 v58, v24, s101, v5
    v_and_or_b32 v59, v28, s101, v5
    s_cmp_eq_u32 s98, 0
    s_cbranch_scc1 Lps_22
    buffer_store_dwordx4 v[56:59], v14, s[44:47], s70 offen
    s_branch Lps_23
Lps_22:
    buffer_store_dwordx4 v[56:59], v14, s[44:47], s70 offen sc1
Lps_23:
L_M_fin:
    s_cmp_ge_u32 s3, 2
    s_cbranch_scc1 L_exit
Lpoll_24:
    buffer_load_dwordx4 v[64:67], v96, s[44:47], s48 offen sc1
    buffer_load_dwordx4 v[68:71], v97, s[44:47], s48 offen sc1
    buffer_load_dwordx4 v[72:75], v98, s[44:47], s48 offen sc1
    s_mov_b32 exec_hi, 0
    buffer_load_dwordx4 v[76:79], v99, s[44:47], s48 offen sc1
    s_mov_b32 exec_hi, -1
    s_waitcnt vmcnt(0)
    v_xor_b32 v16, s100, v64
    v_xor_b32 v17, s100, v65
    v_xor_b32 v18, s100, v66
    v_xor_b32 v19, s100, v67
    v_xor_b32 v20, s100, v68
    v_xor_b32 v21, s100, v69
    v_xor_b32 v22, s100, v70
    v_xor_b32 v23, s100, v71
    v_xor_b32 v24, s100, v72
    v_xor_b32 v25, s100, v73
    v_xor_b32 v26, s100, v74
    v_xor_b32 v27, s100, v75
    v_xor_b32 v28, s100, v76
    v_xor_b32 v29, s100, v77
    v_xor_b32 v30, s100, v78
    v_xor_b32 v31, s100, v79
    v_or3_b32 v11, v16, v17, v18
    v_or3_b32 v11, v19, v20, v11
    v_or3_b32 v11, v21, v22, v11
    v_or3_b32 v11, v23, v24, v11
    v_or3_b32 v11, v25, v26, v11
    v_or3_b32 v11, v27, v28, v11
    v_or3_b32 v11, v29, v30, v11
    v_or_b32 v11, v31, v11
    v_and_b32 v11, 0xff, v11
    v_cmp_ne_u32 vcc, 0, v11
    s_cbranch_vccz Lgot_25
    s_sub_u32 s7, s7, 1
    s_cbranch_scc0 Lpoll_24
    s_branch L_exit
Lgot_25:
    v_pk_add_f32 v[16:17], v[16:17], v[20:21]
    v_pk_add_f32 v[18:19], v[18:19], v[22:23]
    v_pk_add_f32 v[20:21], v[24:25], v[28:29]
    v_pk_add_f32 v[22:23], v[26:27], v[30:31]
    v_pk_add_f32 v[16:17], v[16:17], v[20:21]
    v_pk_add_f32 v[18:19], v[18:19], v[22:23]
    s_nop 0
    v_permlane32_swap_b32 v16, v17
    v_permlane32_swap_b32 v18, v19
    v_add_f32 v16, v16, v17
    v_add_f32 v18, v18, v19
    s_nop 1
    v_permlane16_swap_b32 v16, v18
    v_add_f32 v16, v16, v18
    s_nop 1
    v_add_f32_dpp v16, v16, v16 row_ror:8 row_mask:0xf bank_mask:0xf
    v_cvt_pk_bf16_f32 v16, v16, v16
    v_lshlrev_b32 v16, 16, v16
    v_mul_f32 v16, v16, v120
    v_cvt_pk_bf16_f32 v16, v16, v16
    v_lshlrev_b32 v16, 16, v16
    v_add_f32 v118, v16, v118
    v_mov_b32 v16, v118
    v_mov_b32 v17, v118
    s_nop 1
    v_permlane32_swap_b32 v16, v17
    v_cvt_pk_bf16_f32 v108, v16, v17
    s_mov_b64 exec, 0x00ff00ff
    buffer_store_dword v108, v114, s[56:59], s77 offen
    s_branch L_exit
L_exit:
L_end:
    s_endpgm
.section .rodata,"a"
.p2align 6
.amdhsa_kernel adaLN_cond__sliding_block_cached__glu_gated_swiglu__decode_kernel
  .amdhsa_next_free_vgpr 256
  .amdhsa_next_free_sgpr 102
  .amdhsa_accum_offset 256
  .amdhsa_group_segment_fixed_size 0
  .amdhsa_kernarg_size 112
  .amdhsa_user_sgpr_count 2
  .amdhsa_user_sgpr_kernarg_segment_ptr 1
  .amdhsa_system_sgpr_workgroup_id_x 1
  .amdhsa_float_denorm_mode_32 3
.end_amdhsa_kernel
```
